```python
import torch

def _softmax(x, axis=-1):
    return torch.softmax(x, dim=axis)
def _gelu(x):
    return torch.nn.functional.gelu(x, approximate="tanh")
def _silu(x):
    return torch.nn.functional.silu(x)
def _sigmoid(x):
    return torch.sigmoid(x)
def _layernorm(x, axis=-1, eps=1e-5):
    m = x.mean(dim=axis, keepdim=True)
    v = x.var(dim=axis, keepdim=True, unbiased=False)
    return (x - m) / torch.sqrt(v + eps)
def _scatter_add(tgt, idx, src, axis=0):
    return tgt.clone().index_add_(axis, idx, src)
def _segment_sum(src, seg, n):
    out = torch.zeros((n,) + src.shape[1:], dtype=src.dtype)
    return out.index_add_(0, seg, src)
def _pad(x, pw):
    flat = tuple(v for pair in reversed(pw) for v in pair)
    return torch.nn.functional.pad(x, flat)

kernel_name = 'gated_mix__mha_block_cached__swiglu_ffn__decode'

def setup_inputs():

    _w = (lambda a: (lambda t: t.to(torch.bfloat16) if t.is_floating_point() else t)(torch.as_tensor(a)))
    def _A_setup():
        B, Sq, D = 2, 1, 640
        H, Sk, Dh = 32, 8192, 128
        return {
            "x": _w((lambda *s: torch.randn(*s, dtype=torch.bfloat16) * 0.05)(B, Sq, D)),
            "k_cache": _w((lambda *s: torch.randn(*s, dtype=torch.bfloat16) * 6.4)(B, H, Sk, Dh)),
            "v_cache": _w((lambda *s: torch.randn(*s, dtype=torch.bfloat16) * 0.2)(B, H, Sk, Dh)),
            "wq": _w((lambda *s: torch.randn(*s, dtype=torch.bfloat16) * 6.4)(D, H * Dh) * (D ** -0.5)),
            "wo": _w((lambda *s: torch.randn(*s, dtype=torch.bfloat16) * 0.2)(H * Dh, D) * ((H * Dh) ** -0.5)),
        }
    _A_in = _A_setup()

    def _B_setup():
        B, S, D, F = 2, 1, 640, 1728
        return {
            "x": _w((lambda *s: torch.randn(*s, dtype=torch.bfloat16) * 0.05)(B, S, D)),
            "w_gate": _w((lambda *s: torch.randn(*s, dtype=torch.bfloat16) * 0.05)(D, F)),
            "w_up": _w((lambda *s: torch.randn(*s, dtype=torch.bfloat16) * 0.05)(D, F)),
            "w_down": _w((lambda *s: torch.randn(*s, dtype=torch.bfloat16) * 0.05)(F, D)),
        }
    _B_in = _B_setup()

    return {
        "A_x": _A_in["x"],
        "A_k_cache": _A_in["k_cache"],
        "A_v_cache": _A_in["v_cache"],
        "A_wq": _A_in["wq"],
        "A_wo": _A_in["wo"],
        "B_x": _B_in["x"],
        "B_w_gate": _B_in["w_gate"],
        "B_w_up": _B_in["w_up"],
        "B_w_down": _B_in["w_down"],
        "gate_w": _w((lambda *s: torch.randn(*s, dtype=torch.bfloat16) * 0.05)(640) * 16.0),
    }

def reference(A_x, A_k_cache, A_v_cache, A_wq, A_wo, B_x, B_w_gate, B_w_up, B_w_down, gate_w):
    def _A_ref(x, k_cache, v_cache, wq, wo):
        B, Sq, D = x.shape
        H, Dh = 32, 128
        q = (lambda x, *d: x.permute(*d))((x @ wq).reshape(B, Sq, H, Dh), 0, 2, 1, 3)
        scores = torch.einsum("bhqd,bhkd->bhqk", q, k_cache) * (Dh ** -0.5)
        p = _softmax(scores, axis=-1)
        o = torch.einsum("bhqk,bhkd->bhqd", p, v_cache)
        return (lambda x, *d: x.permute(*d))(o, 0, 2, 1, 3).reshape(B, Sq, H * Dh) @ wo

    def _B_ref(x, w_gate, w_up, w_down):
        g = _silu(x @ w_gate)
        u = x @ w_up
        return (g * u) @ w_down

    x = A_x
    g = _sigmoid((x * gate_w).sum(-1, keepdims=True))
    a = _A_ref(x, A_k_cache, A_v_cache, A_wq, A_wo)
    b = _B_ref(x, B_w_gate, B_w_up, B_w_down)
    return g * a + (1 - g) * b
```

```asm
; @launch grid=(256,1,1) block=(512,1,1) lds=48128
.amdgcn_target "amdgcn-amd-amdhsa--gfx950"
.text
.globl gated_mix__mha_block_cached__swiglu_ffn__decode_kernel
.p2align 8
.type gated_mix__mha_block_cached__swiglu_ffn__decode_kernel,@function
gated_mix__mha_block_cached__swiglu_ffn__decode_kernel:
  s_cmp_ge_u32 s2, 0x100
  s_cbranch_scc1 L_end
  s_load_dwordx2 s[8:9], s[0:1], 8
  s_load_dwordx2 s[12:13], s[0:1], 16
  s_load_dwordx2 s[16:17], s[0:1], 96
  v_readfirstlane_b32 s3, v0
  s_and_b32 s4, s2, 7
  s_lshl_b32 s4, s4, 2
  s_lshr_b32 s5, s2, 6
  s_lshl_b32 s5, s5, 3
  s_lshr_b32 s94, 0x76543210, s4
  s_lshr_b32 s4, 0x76543210, s4
  s_and_b32 s94, s94, 7
  s_and_b32 s4, s4, 7
  s_add_u32 s94, s94, s5
  s_add_u32 s4, s4, s5
  s_bfe_u32 s5, s2, 0x30003
  s_lshr_b32 s6, s5, 2
  s_and_b32 s7, s5, 3
  s_lshl_b32 s22, s6, 7
  s_lshl_b32 s23, s4, 2
  s_add_u32 s22, s22, s23
  s_add_u32 s22, s22, s7
  v_and_b32 v1, 63, v0
  s_lshr_b32 s3, s3, 6
  s_cmp_ge_u32 s3, 4
  s_cbranch_scc1 L_helper
  v_and_b32 v4, 3, v1
  v_lshlrev_b32 v4, 4, v4
  v_bfe_u32 v5, v1, 2, 2
  v_lshl_add_u32 v4, v5, 8, v4
  v_lshrrev_b32 v5, 4, v1
  v_lshl_add_u32 v4, v5, 6, v4
  s_lshl_b32 s23, s3, 12
  v_add_u32 v2, s23, v4
  v_lshlrev_b32 v7, 4, v1
  v_add_u32 v3, s23, v7
  s_lshl_b32 s20, s22, 19
  s_mov_b32 s23, s20
  s_mov_b32 s21, 0x4000
  s_lshl_b32 s31, s7, 19
  s_sub_u32 s30, s20, s31
  s_mov_b32 s32, s30
  s_mov_b32 s33, s31
  s_mov_b32 s10, 0x8000000
  s_mov_b32 s11, 0x20000
  s_mov_b32 s14, 0x8000000
  s_mov_b32 s15, 0x20000
  s_mov_b32 s18, 0x400000
  s_mov_b32 s19, 0x20000
  s_waitcnt lgkmcnt(0)
  s_load_dword s95, s[16:17], 0xb0000
  buffer_load_dwordx4 v[64:67], v2, s[8:11], s20 offen offset:0 nt
  buffer_load_dwordx4 v[68:71], v2, s[8:11], s20 offen offset:1024 nt
  buffer_load_dwordx4 v[72:75], v2, s[8:11], s20 offen offset:2048 nt
  buffer_load_dwordx4 v[76:79], v2, s[8:11], s20 offen offset:3072 nt
  s_add_u32 s30, s30, s21
  s_add_u32 s31, s31, 0x80000
  s_and_b32 s31, s31, 0x180000
  s_add_u32 s20, s30, s31
  buffer_load_dwordx4 v[80:83], v2, s[8:11], s20 offen offset:0 nt
  buffer_load_dwordx4 v[84:87], v2, s[8:11], s20 offen offset:1024 nt
  buffer_load_dwordx4 v[88:91], v2, s[8:11], s20 offen offset:2048 nt
  buffer_load_dwordx4 v[92:95], v2, s[8:11], s20 offen offset:3072 nt
  s_add_u32 s30, s30, s21
  s_add_u32 s31, s31, 0x80000
  s_and_b32 s31, s31, 0x180000
  s_add_u32 s20, s30, s31
  s_branch L_stream2
L_helper:
  s_load_dwordx2 s[68:69], s[0:1], 0
  s_load_dwordx2 s[96:97], s[0:1], 24
  s_load_dwordx2 s[40:41], s[0:1], 32
  s_load_dwordx4 s[24:27], s[0:1], 48
  s_load_dwordx4 s[32:35], s[0:1], 64
  s_load_dwordx2 s[44:45], s[0:1], 80
  s_sub_u32 s3, s3, 4
  v_lshrrev_b32 v5, 4, v1
  v_and_b32 v6, 15, v1
  s_mov_b32 s70, 0xa00
  s_mov_b32 s71, 0x20000
  s_mov_b32 s98, 0x500000
  s_mov_b32 s99, 0x20000
  s_cmp_eq_u32 s3, 0
  s_cbranch_scc0 L_h_notq
  s_mul_i32 s20, s5, 80
  v_add_u32 v2, s20, v5
  v_lshlrev_b32 v2, 1, v2
  v_bfe_u32 v3, v1, 3, 1
  v_mul_u32_u24 v3, 1280, v3
  v_add_u32 v2, v2, v3
  v_lshlrev_b32 v3, 13, v5
  v_lshl_add_u32 v3, v6, 4, v3
  s_mul_i32 s20, s5, 655360
  s_lshl_b32 s21, s4, 8
  s_add_u32 s20, s20, s21
  s_mov_b32 s21, 0x8000
  s_waitcnt lgkmcnt(0)
  buffer_load_dwordx4 v[96:99], v3, s[96:99], s20 offen nt
  buffer_load_ushort v50, v2, s[68:71], 0 offen offset:0
  s_add_u32 s20, s20, s21
  buffer_load_dwordx4 v[100:103], v3, s[96:99], s20 offen nt
  buffer_load_ushort v51, v2, s[68:71], 0 offen offset:8
  s_add_u32 s20, s20, s21
  buffer_load_dwordx4 v[104:107], v3, s[96:99], s20 offen nt
  buffer_load_ushort v52, v2, s[68:71], 0 offen offset:16
  s_add_u32 s20, s20, s21
  buffer_load_dwordx4 v[108:111], v3, s[96:99], s20 offen nt
  buffer_load_ushort v53, v2, s[68:71], 0 offen offset:24
  s_add_u32 s20, s20, s21
  buffer_load_dwordx4 v[112:115], v3, s[96:99], s20 offen nt
  buffer_load_ushort v54, v2, s[68:71], 0 offen offset:32
  s_add_u32 s20, s20, s21
  buffer_load_dwordx4 v[116:119], v3, s[96:99], s20 offen nt
  buffer_load_ushort v55, v2, s[68:71], 0 offen offset:40
  s_add_u32 s20, s20, s21
  buffer_load_dwordx4 v[120:123], v3, s[96:99], s20 offen nt
  buffer_load_ushort v56, v2, s[68:71], 0 offen offset:48
  s_add_u32 s20, s20, s21
  buffer_load_dwordx4 v[124:127], v3, s[96:99], s20 offen nt
  buffer_load_ushort v57, v2, s[68:71], 0 offen offset:56
  s_add_u32 s20, s20, s21
  buffer_load_dwordx4 v[128:131], v3, s[96:99], s20 offen nt
  buffer_load_ushort v58, v2, s[68:71], 0 offen offset:64
  s_add_u32 s20, s20, s21
  buffer_load_dwordx4 v[132:135], v3, s[96:99], s20 offen nt
  buffer_load_ushort v59, v2, s[68:71], 0 offen offset:72
  s_add_u32 s20, s20, s21
  buffer_load_dwordx4 v[136:139], v3, s[96:99], s20 offen nt
  buffer_load_ushort v60, v2, s[68:71], 0 offen offset:80
  s_add_u32 s20, s20, s21
  buffer_load_dwordx4 v[140:143], v3, s[96:99], s20 offen nt
  buffer_load_ushort v61, v2, s[68:71], 0 offen offset:88
  s_add_u32 s20, s20, s21
  buffer_load_dwordx4 v[144:147], v3, s[96:99], s20 offen nt
  buffer_load_ushort v62, v2, s[68:71], 0 offen offset:96
  s_add_u32 s20, s20, s21
  buffer_load_dwordx4 v[148:151], v3, s[96:99], s20 offen nt
  buffer_load_ushort v63, v2, s[68:71], 0 offen offset:104
  s_add_u32 s20, s20, s21
  buffer_load_dwordx4 v[152:155], v3, s[96:99], s20 offen nt
  buffer_load_ushort v64, v2, s[68:71], 0 offen offset:112
  s_add_u32 s20, s20, s21
  buffer_load_dwordx4 v[156:159], v3, s[96:99], s20 offen nt
  buffer_load_ushort v65, v2, s[68:71], 0 offen offset:120
  s_add_u32 s20, s20, s21
  buffer_load_dwordx4 v[160:163], v3, s[96:99], s20 offen nt
  buffer_load_ushort v66, v2, s[68:71], 0 offen offset:128
  s_add_u32 s20, s20, s21
  buffer_load_dwordx4 v[164:167], v3, s[96:99], s20 offen nt
  buffer_load_ushort v67, v2, s[68:71], 0 offen offset:136
  s_add_u32 s20, s20, s21
  buffer_load_dwordx4 v[168:171], v3, s[96:99], s20 offen nt
  buffer_load_ushort v68, v2, s[68:71], 0 offen offset:144
  s_add_u32 s20, s20, s21
  buffer_load_dwordx4 v[172:175], v3, s[96:99], s20 offen nt
  buffer_load_ushort v69, v2, s[68:71], 0 offen offset:152
  s_load_dword s95, s[16:17], 0xb0000
  s_mov_b32 s28, s26
  s_mov_b32 s29, s27
  s_mov_b32 s26, 0x21c000
  s_mov_b32 s27, 0x20000
  s_mov_b32 s30, 0x21c000
  s_mov_b32 s31, 0x20000
  s_mov_b32 s36, s34
  s_mov_b32 s37, s35
  s_mov_b32 s34, 0x21c000
  s_mov_b32 s35, 0x20000
  s_mov_b32 s38, 0x500
  s_mov_b32 s39, 0x20000
  s_mov_b32 s42, 0x500000
  s_mov_b32 s43, 0x20000
  s_mov_b32 s46, 0xa00
  s_mov_b32 s47, 0x20000
  s_mov_b32 s18, 0x400000
  s_mov_b32 s19, 0x20000
  v_and_b32 v4, 1, v6
  v_lshlrev_b32 v4, 4, v4
  v_mov_b32 v7, 1
  v_lshlrev_b32 v7, v4, v7
  v_bfe_u32 v4, v6, 1, 2
  v_cmp_eq_u32 vcc, 0, v4
  s_nop 1
  v_cndmask_b32 v44, 0, v7, vcc
  v_cmp_eq_u32 vcc, 1, v4
  s_nop 1
  v_cndmask_b32 v45, 0, v7, vcc
  v_cmp_eq_u32 vcc, 2, v4
  s_nop 1
  v_cndmask_b32 v46, 0, v7, vcc
  v_cmp_eq_u32 vcc, 3, v4
  s_nop 1
  v_cndmask_b32 v47, 0, v7, vcc
  v_lshlrev_b32 v2, 4, v1
  s_lshl_b32 s20, s4, 13
  s_add_u32 s20, s20, 0x240000
  s_lshl_b32 s21, s5, 10
  s_add_u32 s52, s20, s21
  s_lshl_b32 s21, s6, 7
  s_add_u32 s53, s20, s21
  s_add_u32 s54, s53, 0x1000
  v_lshrrev_b32 v3, 5, v1
  v_lshlrev_b32 v3, 10, v3
  v_bfe_u32 v4, v1, 3, 2
  v_lshl_add_u32 v3, v4, 8, v3
  v_and_b32 v4, 7, v1
  v_lshl_add_u32 v3, v4, 4, v3
  s_waitcnt lgkmcnt(0)
  s_add_u32 s95, s95, 1
  s_and_b32 s93, s95, 0x3ff
  s_mov_b32 s92, 0xfffffc00
  v_mov_b32 v48, s93
  s_waitcnt vmcnt(38)
  v_mul_u32_u24 v12, v50, v44
  v_mul_u32_u24 v13, v50, v45
  v_mul_u32_u24 v14, v50, v46
  v_mul_u32_u24 v15, v50, v47
  s_nop 1
  v_mfma_f32_16x16x32_bf16 v[20:23], v[96:99], v[12:15], 0
  s_waitcnt vmcnt(36)
  v_mul_u32_u24 v16, v51, v44
  v_mul_u32_u24 v17, v51, v45
  v_mul_u32_u24 v18, v51, v46
  v_mul_u32_u24 v19, v51, v47
  s_nop 1
  v_mfma_f32_16x16x32_bf16 v[20:23], v[100:103], v[16:19], v[20:23]
  s_waitcnt vmcnt(34)
  v_mul_u32_u24 v12, v52, v44
  v_mul_u32_u24 v13, v52, v45
  v_mul_u32_u24 v14, v52, v46
  v_mul_u32_u24 v15, v52, v47
  s_nop 1
  v_mfma_f32_16x16x32_bf16 v[20:23], v[104:107], v[12:15], v[20:23]
  s_waitcnt vmcnt(32)
  v_mul_u32_u24 v16, v53, v44
  v_mul_u32_u24 v17, v53, v45
  v_mul_u32_u24 v18, v53, v46
  v_mul_u32_u24 v19, v53, v47
  s_nop 1
  v_mfma_f32_16x16x32_bf16 v[20:23], v[108:111], v[16:19], v[20:23]
  s_waitcnt vmcnt(30)
  v_mul_u32_u24 v12, v54, v44
  v_mul_u32_u24 v13, v54, v45
  v_mul_u32_u24 v14, v54, v46
  v_mul_u32_u24 v15, v54, v47
  s_nop 1
  v_mfma_f32_16x16x32_bf16 v[20:23], v[112:115], v[12:15], v[20:23]
  s_waitcnt vmcnt(28)
  v_mul_u32_u24 v16, v55, v44
  v_mul_u32_u24 v17, v55, v45
  v_mul_u32_u24 v18, v55, v46
  v_mul_u32_u24 v19, v55, v47
  s_nop 1
  v_mfma_f32_16x16x32_bf16 v[20:23], v[116:119], v[16:19], v[20:23]
  s_waitcnt vmcnt(26)
  v_mul_u32_u24 v12, v56, v44
  v_mul_u32_u24 v13, v56, v45
  v_mul_u32_u24 v14, v56, v46
  v_mul_u32_u24 v15, v56, v47
  s_nop 1
  v_mfma_f32_16x16x32_bf16 v[20:23], v[120:123], v[12:15], v[20:23]
  s_waitcnt vmcnt(24)
  v_mul_u32_u24 v16, v57, v44
  v_mul_u32_u24 v17, v57, v45
  v_mul_u32_u24 v18, v57, v46
  v_mul_u32_u24 v19, v57, v47
  s_nop 1
  v_mfma_f32_16x16x32_bf16 v[20:23], v[124:127], v[16:19], v[20:23]
  s_waitcnt vmcnt(22)
  v_mul_u32_u24 v12, v58, v44
  v_mul_u32_u24 v13, v58, v45
  v_mul_u32_u24 v14, v58, v46
  v_mul_u32_u24 v15, v58, v47
  s_nop 1
  v_mfma_f32_16x16x32_bf16 v[20:23], v[128:131], v[12:15], v[20:23]
  s_waitcnt vmcnt(20)
  v_mul_u32_u24 v16, v59, v44
  v_mul_u32_u24 v17, v59, v45
  v_mul_u32_u24 v18, v59, v46
  v_mul_u32_u24 v19, v59, v47
  s_nop 1
  v_mfma_f32_16x16x32_bf16 v[20:23], v[132:135], v[16:19], v[20:23]
  s_waitcnt vmcnt(18)
  v_mul_u32_u24 v12, v60, v44
  v_mul_u32_u24 v13, v60, v45
  v_mul_u32_u24 v14, v60, v46
  v_mul_u32_u24 v15, v60, v47
  s_nop 1
  v_mfma_f32_16x16x32_bf16 v[20:23], v[136:139], v[12:15], v[20:23]
  s_waitcnt vmcnt(16)
  v_mul_u32_u24 v16, v61, v44
  v_mul_u32_u24 v17, v61, v45
  v_mul_u32_u24 v18, v61, v46
  v_mul_u32_u24 v19, v61, v47
  s_nop 1
  v_mfma_f32_16x16x32_bf16 v[20:23], v[140:143], v[16:19], v[20:23]
  s_waitcnt vmcnt(14)
  v_mul_u32_u24 v12, v62, v44
  v_mul_u32_u24 v13, v62, v45
  v_mul_u32_u24 v14, v62, v46
  v_mul_u32_u24 v15, v62, v47
  s_nop 1
  v_mfma_f32_16x16x32_bf16 v[20:23], v[144:147], v[12:15], v[20:23]
  s_waitcnt vmcnt(12)
  v_mul_u32_u24 v16, v63, v44
  v_mul_u32_u24 v17, v63, v45
  v_mul_u32_u24 v18, v63, v46
  v_mul_u32_u24 v19, v63, v47
  s_nop 1
  v_mfma_f32_16x16x32_bf16 v[20:23], v[148:151], v[16:19], v[20:23]
  s_waitcnt vmcnt(10)
  v_mul_u32_u24 v12, v64, v44
  v_mul_u32_u24 v13, v64, v45
  v_mul_u32_u24 v14, v64, v46
  v_mul_u32_u24 v15, v64, v47
  s_nop 1
  v_mfma_f32_16x16x32_bf16 v[20:23], v[152:155], v[12:15], v[20:23]
  s_waitcnt vmcnt(8)
  v_mul_u32_u24 v16, v65, v44
  v_mul_u32_u24 v17, v65, v45
  v_mul_u32_u24 v18, v65, v46
  v_mul_u32_u24 v19, v65, v47
  s_nop 1
  v_mfma_f32_16x16x32_bf16 v[20:23], v[156:159], v[16:19], v[20:23]
  s_waitcnt vmcnt(6)
  v_mul_u32_u24 v12, v66, v44
  v_mul_u32_u24 v13, v66, v45
  v_mul_u32_u24 v14, v66, v46
  v_mul_u32_u24 v15, v66, v47
  s_nop 1
  v_mfma_f32_16x16x32_bf16 v[20:23], v[160:163], v[12:15], v[20:23]
  s_waitcnt vmcnt(4)
  v_mul_u32_u24 v16, v67, v44
  v_mul_u32_u24 v17, v67, v45
  v_mul_u32_u24 v18, v67, v46
  v_mul_u32_u24 v19, v67, v47
  s_nop 1
  v_mfma_f32_16x16x32_bf16 v[20:23], v[164:167], v[16:19], v[20:23]
  s_waitcnt vmcnt(2)
  v_mul_u32_u24 v12, v68, v44
  v_mul_u32_u24 v13, v68, v45
  v_mul_u32_u24 v14, v68, v46
  v_mul_u32_u24 v15, v68, v47
  s_nop 1
  v_mfma_f32_16x16x32_bf16 v[20:23], v[168:171], v[12:15], v[20:23]
  s_waitcnt vmcnt(0)
  v_mul_u32_u24 v16, v69, v44
  v_mul_u32_u24 v17, v69, v45
  v_mul_u32_u24 v18, v69, v46
  v_mul_u32_u24 v19, v69, v47
  s_nop 1
  v_mfma_f32_16x16x32_bf16 v[20:23], v[172:175], v[16:19], v[20:23]
  s_nop 7
  v_and_or_b32 v20, v20, s92, v48
  v_and_or_b32 v21, v21, s92, v48
  v_and_or_b32 v22, v22, s92, v48
  v_and_or_b32 v23, v23, s92, v48
  buffer_store_dwordx4 v[20:23], v2, s[16:19], s52 offen sc1
  s_mov_b32 s56, 65536
  s_nop 0
L_h_qpoll:
  s_sleep 30
  buffer_load_dwordx4 v[96:99], v3, s[16:19], s53 offen offset:0 sc1
  buffer_load_dwordx4 v[100:103], v3, s[16:19], s53 offen offset:2048 sc1
  buffer_load_dwordx4 v[104:107], v3, s[16:19], s54 offen offset:0 sc1
  buffer_load_dwordx4 v[108:111], v3, s[16:19], s54 offen offset:2048 sc1
  s_waitcnt vmcnt(0)
  v_or3_b32 v80, v96, v97, v98
  v_and_b32 v81, v96, v97
  v_or3_b32 v80, v80, v99, v100
  v_or3_b32 v80, v80, v101, v102
  v_or3_b32 v80, v80, v103, v104
  v_or3_b32 v80, v80, v105, v106
  v_or3_b32 v80, v80, v107, v108
  v_or3_b32 v80, v80, v109, v110
  v_or_b32 v80, v80, v111
  v_and_b32 v81, v81, v98
  v_and_b32 v81, v81, v99
  v_and_b32 v81, v81, v100
  v_and_b32 v81, v81, v101
  v_and_b32 v81, v81, v102
  v_and_b32 v81, v81, v103
  v_and_b32 v81, v81, v104
  v_and_b32 v81, v81, v105
  v_and_b32 v81, v81, v106
  v_and_b32 v81, v81, v107
  v_and_b32 v81, v81, v108
  v_and_b32 v81, v81, v109
  v_and_b32 v81, v81, v110
  v_and_b32 v81, v81, v111
  v_xor_b32 v80, v80, v48
  v_xor_b32 v81, v81, v48
  v_or_b32 v80, v80, v81
  v_and_b32 v80, 0x3ff, v80
  v_cmp_ne_u32 vcc, 0, v80
  s_nop 1
  s_cbranch_vccz L_h_qok
  s_sub_u32 s56, s56, 1
  s_cmp_lg_u32 s56, 0
  s_cbranch_scc1 L_h_qpoll
L_h_qok:
  v_add_f32 v96, v96, v100
  v_add_f32 v104, v104, v108
  v_add_f32 v97, v97, v101
  v_add_f32 v105, v105, v109
  v_add_f32 v98, v98, v102
  v_add_f32 v106, v106, v110
  v_add_f32 v99, v99, v103
  v_add_f32 v107, v107, v111
  v_add_f32 v96, v96, v104
  v_add_f32 v97, v97, v105
  v_add_f32 v98, v98, v106
  v_add_f32 v99, v99, v107
  v_mov_b32 v100, v96
  v_mov_b32 v101, v97
  v_mov_b32 v102, v98
  v_mov_b32 v103, v99
  v_permlane32_swap_b32 v100, v96
  v_permlane32_swap_b32 v101, v97
  v_permlane32_swap_b32 v102, v98
  v_permlane32_swap_b32 v103, v99
  v_add_f32 v96, v96, v100
  v_add_f32 v97, v97, v101
  v_add_f32 v98, v98, v102
  v_add_f32 v99, v99, v103
  v_bfe_u32 v3, v1, 3, 2
  v_lshlrev_b32 v3, 7, v3
  v_lshl_add_u32 v3, v4, 2, v3
  s_mov_b32 exec_lo, -1
  s_mov_b32 exec_hi, 0
  ds_write_b32 v3, v96 offset:0
  ds_write_b32 v3, v97 offset:32
  ds_write_b32 v3, v98 offset:64
  ds_write_b32 v3, v99 offset:96
  s_mov_b64 exec, -1
  s_waitcnt lgkmcnt(0)
  s_branch L_h_b1
L_h_notq:
  s_waitcnt lgkmcnt(0)
  s_load_dword s95, s[16:17], 0xb0000
  s_mov_b32 s28, s26
  s_mov_b32 s29, s27
  s_mov_b32 s26, 0x21c000
  s_mov_b32 s27, 0x20000
  s_mov_b32 s30, 0x21c000
  s_mov_b32 s31, 0x20000
  s_mov_b32 s36, s34
  s_mov_b32 s37, s35
  s_mov_b32 s34, 0x21c000
  s_mov_b32 s35, 0x20000
  s_mov_b32 s38, 0x500
  s_mov_b32 s39, 0x20000
  s_mov_b32 s42, 0x500000
  s_mov_b32 s43, 0x20000
  s_mov_b32 s46, 0xa00
  s_mov_b32 s47, 0x20000
  s_mov_b32 s18, 0x400000
  s_mov_b32 s19, 0x20000
L_h_nof1:
  v_and_b32 v4, 1, v6
  v_lshlrev_b32 v4, 4, v4
  v_mov_b32 v3, 1
  v_lshlrev_b32 v3, v4, v3
  v_bfe_u32 v4, v6, 1, 2
  v_cmp_eq_u32 vcc, 0, v4
  s_nop 1
  v_cndmask_b32 v44, 0, v3, vcc
  v_cmp_eq_u32 vcc, 1, v4
  s_nop 1
  v_cndmask_b32 v45, 0, v3, vcc
  v_cmp_eq_u32 vcc, 2, v4
  s_nop 1
  v_cndmask_b32 v46, 0, v3, vcc
  v_cmp_eq_u32 vcc, 3, v4
  s_nop 1
  v_cndmask_b32 v47, 0, v3, vcc
  s_waitcnt lgkmcnt(0)
  s_add_u32 s95, s95, 1
  s_and_b32 s93, s95, 0x3ff
  s_mov_b32 s92, 0xfffffc00
  v_mov_b32 v48, s93
  s_nop 1
L_h_b1:
  v_and_b32 v7, 7, v1
  v_lshl_add_u32 v7, v5, 3, v7
  v_lshlrev_b32 v7, 4, v7
  v_and_b32 v4, 1, v6
  v_lshlrev_b32 v4, 4, v4
  v_mov_b32 v3, 0xffff
  v_lshlrev_b32 v3, v4, v3
  v_lshrrev_b32 v4, 1, v6
  v_cmp_eq_u32 vcc, 0, v4
  s_nop 1
  v_cndmask_b32 v8, 0, v3, vcc
  v_cmp_eq_u32 vcc, 1, v4
  s_nop 1
  v_cndmask_b32 v9, 0, v3, vcc
  v_cmp_eq_u32 vcc, 2, v4
  s_nop 1
  v_cndmask_b32 v10, 0, v3, vcc
  v_cmp_eq_u32 vcc, 3, v4
  s_nop 1
  v_cndmask_b32 v11, 0, v3, vcc
  s_barrier
  s_cmp_lg_u32 s3, 1
  s_cbranch_scc1 L_h_wo
  s_cmp_ge_u32 s94, 27
  s_cbranch_scc1 L_h_wo
  s_mul_i32 s20, s5, 80
  v_add_u32 v2, s20, v5
  v_lshlrev_b32 v2, 1, v2
  v_bfe_u32 v3, v1, 3, 1
  v_mul_u32_u24 v3, 1280, v3
  v_add_u32 v2, v2, v3
  buffer_load_ushort v50, v2, s[68:71], 0 offen offset:0
  buffer_load_ushort v51, v2, s[68:71], 0 offen offset:8
  buffer_load_ushort v52, v2, s[68:71], 0 offen offset:16
  buffer_load_ushort v53, v2, s[68:71], 0 offen offset:24
  buffer_load_ushort v54, v2, s[68:71], 0 offen offset:32
  buffer_load_ushort v55, v2, s[68:71], 0 offen offset:40
  buffer_load_ushort v56, v2, s[68:71], 0 offen offset:48
  buffer_load_ushort v57, v2, s[68:71], 0 offen offset:56
  buffer_load_ushort v58, v2, s[68:71], 0 offen offset:64
  buffer_load_ushort v59, v2, s[68:71], 0 offen offset:72
  buffer_load_ushort v60, v2, s[68:71], 0 offen offset:80
  buffer_load_ushort v61, v2, s[68:71], 0 offen offset:88
  buffer_load_ushort v62, v2, s[68:71], 0 offen offset:96
  buffer_load_ushort v63, v2, s[68:71], 0 offen offset:104
  buffer_load_ushort v64, v2, s[68:71], 0 offen offset:112
  buffer_load_ushort v65, v2, s[68:71], 0 offen offset:120
  buffer_load_ushort v66, v2, s[68:71], 0 offen offset:128
  buffer_load_ushort v67, v2, s[68:71], 0 offen offset:136
  buffer_load_ushort v68, v2, s[68:71], 0 offen offset:144
  buffer_load_ushort v69, v2, s[68:71], 0 offen offset:152
  v_mul_u32_u24 v2, 3456, v5
  v_and_b32 v3, 7, v1
  v_lshl_add_u32 v2, v3, 4, v2
  s_mul_i32 s52, s5, 276480
  s_lshl_b32 s21, s94, 7
  s_add_u32 s52, s52, s21
  s_mov_b32 s21, 13824
  s_mov_b32 s20, s52
  s_mov_b32 exec_lo, 0xff00ff
  s_mov_b32 exec_hi, 0xff00ff
  buffer_load_dwordx4 v[96:99], v2, s[24:27], s20 offen nt
  s_add_u32 s20, s20, s21
  buffer_load_dwordx4 v[100:103], v2, s[24:27], s20 offen nt
  s_add_u32 s20, s20, s21
  buffer_load_dwordx4 v[104:107], v2, s[24:27], s20 offen nt
  s_add_u32 s20, s20, s21
  buffer_load_dwordx4 v[108:111], v2, s[24:27], s20 offen nt
  s_add_u32 s20, s20, s21
  buffer_load_dwordx4 v[112:115], v2, s[24:27], s20 offen nt
  s_add_u32 s20, s20, s21
  buffer_load_dwordx4 v[116:119], v2, s[24:27], s20 offen nt
  s_add_u32 s20, s20, s21
  buffer_load_dwordx4 v[120:123], v2, s[24:27], s20 offen nt
  s_add_u32 s20, s20, s21
  buffer_load_dwordx4 v[124:127], v2, s[24:27], s20 offen nt
  s_add_u32 s20, s20, s21
  buffer_load_dwordx4 v[128:131], v2, s[24:27], s20 offen nt
  s_add_u32 s20, s20, s21
  buffer_load_dwordx4 v[132:135], v2, s[24:27], s20 offen nt
  s_add_u32 s20, s20, s21
  buffer_load_dwordx4 v[136:139], v2, s[24:27], s20 offen nt
  s_add_u32 s20, s20, s21
  buffer_load_dwordx4 v[140:143], v2, s[24:27], s20 offen nt
  s_add_u32 s20, s20, s21
  buffer_load_dwordx4 v[144:147], v2, s[24:27], s20 offen nt
  s_add_u32 s20, s20, s21
  buffer_load_dwordx4 v[148:151], v2, s[24:27], s20 offen nt
  s_add_u32 s20, s20, s21
  buffer_load_dwordx4 v[152:155], v2, s[24:27], s20 offen nt
  s_add_u32 s20, s20, s21
  buffer_load_dwordx4 v[156:159], v2, s[24:27], s20 offen nt
  s_add_u32 s20, s20, s21
  buffer_load_dwordx4 v[160:163], v2, s[24:27], s20 offen nt
  s_add_u32 s20, s20, s21
  buffer_load_dwordx4 v[164:167], v2, s[24:27], s20 offen nt
  s_add_u32 s20, s20, s21
  buffer_load_dwordx4 v[168:171], v2, s[24:27], s20 offen nt
  s_add_u32 s20, s20, s21
  buffer_load_dwordx4 v[172:175], v2, s[24:27], s20 offen nt
  s_mov_b32 s20, s52
  s_mov_b32 exec_lo, 0xff00ff00
  s_mov_b32 exec_hi, 0xff00ff00
  buffer_load_dwordx4 v[96:99], v2, s[28:31], s20 offen nt
  s_add_u32 s20, s20, s21
  buffer_load_dwordx4 v[100:103], v2, s[28:31], s20 offen nt
  s_add_u32 s20, s20, s21
  buffer_load_dwordx4 v[104:107], v2, s[28:31], s20 offen nt
  s_add_u32 s20, s20, s21
  buffer_load_dwordx4 v[108:111], v2, s[28:31], s20 offen nt
  s_add_u32 s20, s20, s21
  buffer_load_dwordx4 v[112:115], v2, s[28:31], s20 offen nt
  s_add_u32 s20, s20, s21
  buffer_load_dwordx4 v[116:119], v2, s[28:31], s20 offen nt
  s_add_u32 s20, s20, s21
  buffer_load_dwordx4 v[120:123], v2, s[28:31], s20 offen nt
  s_add_u32 s20, s20, s21
  buffer_load_dwordx4 v[124:127], v2, s[28:31], s20 offen nt
  s_add_u32 s20, s20, s21
  buffer_load_dwordx4 v[128:131], v2, s[28:31], s20 offen nt
  s_add_u32 s20, s20, s21
  buffer_load_dwordx4 v[132:135], v2, s[28:31], s20 offen nt
  s_add_u32 s20, s20, s21
  buffer_load_dwordx4 v[136:139], v2, s[28:31], s20 offen nt
  s_add_u32 s20, s20, s21
  buffer_load_dwordx4 v[140:143], v2, s[28:31], s20 offen nt
  s_add_u32 s20, s20, s21
  buffer_load_dwordx4 v[144:147], v2, s[28:31], s20 offen nt
  s_add_u32 s20, s20, s21
  buffer_load_dwordx4 v[148:151], v2, s[28:31], s20 offen nt
  s_add_u32 s20, s20, s21
  buffer_load_dwordx4 v[152:155], v2, s[28:31], s20 offen nt
  s_add_u32 s20, s20, s21
  buffer_load_dwordx4 v[156:159], v2, s[28:31], s20 offen nt
  s_add_u32 s20, s20, s21
  buffer_load_dwordx4 v[160:163], v2, s[28:31], s20 offen nt
  s_add_u32 s20, s20, s21
  buffer_load_dwordx4 v[164:167], v2, s[28:31], s20 offen nt
  s_add_u32 s20, s20, s21
  buffer_load_dwordx4 v[168:171], v2, s[28:31], s20 offen nt
  s_add_u32 s20, s20, s21
  buffer_load_dwordx4 v[172:175], v2, s[28:31], s20 offen nt
  s_mov_b64 exec, -1
  s_waitcnt vmcnt(19)
  v_mul_u32_u24 v12, v50, v44
  v_mul_u32_u24 v13, v50, v45
  v_mul_u32_u24 v14, v50, v46
  v_mul_u32_u24 v15, v50, v47
  s_nop 1
  v_mfma_f32_16x16x32_bf16 v[20:23], v[96:99], v[12:15], 0
  s_waitcnt vmcnt(18)
  v_mul_u32_u24 v16, v51, v44
  v_mul_u32_u24 v17, v51, v45
  v_mul_u32_u24 v18, v51, v46
  v_mul_u32_u24 v19, v51, v47
  s_nop 1
  v_mfma_f32_16x16x32_bf16 v[20:23], v[100:103], v[16:19], v[20:23]
  s_waitcnt vmcnt(17)
  v_mul_u32_u24 v12, v52, v44
  v_mul_u32_u24 v13, v52, v45
  v_mul_u32_u24 v14, v52, v46
  v_mul_u32_u24 v15, v52, v47
  s_nop 1
  v_mfma_f32_16x16x32_bf16 v[20:23], v[104:107], v[12:15], v[20:23]
  s_waitcnt vmcnt(16)
  v_mul_u32_u24 v16, v53, v44
  v_mul_u32_u24 v17, v53, v45
  v_mul_u32_u24 v18, v53, v46
  v_mul_u32_u24 v19, v53, v47
  s_nop 1
  v_mfma_f32_16x16x32_bf16 v[20:23], v[108:111], v[16:19], v[20:23]
  s_waitcnt vmcnt(15)
  v_mul_u32_u24 v12, v54, v44
  v_mul_u32_u24 v13, v54, v45
  v_mul_u32_u24 v14, v54, v46
  v_mul_u32_u24 v15, v54, v47
  s_nop 1
  v_mfma_f32_16x16x32_bf16 v[20:23], v[112:115], v[12:15], v[20:23]
  s_waitcnt vmcnt(14)
  v_mul_u32_u24 v16, v55, v44
  v_mul_u32_u24 v17, v55, v45
  v_mul_u32_u24 v18, v55, v46
  v_mul_u32_u24 v19, v55, v47
  s_nop 1
  v_mfma_f32_16x16x32_bf16 v[20:23], v[116:119], v[16:19], v[20:23]
  s_waitcnt vmcnt(13)
  v_mul_u32_u24 v12, v56, v44
  v_mul_u32_u24 v13, v56, v45
  v_mul_u32_u24 v14, v56, v46
  v_mul_u32_u24 v15, v56, v47
  s_nop 1
  v_mfma_f32_16x16x32_bf16 v[20:23], v[120:123], v[12:15], v[20:23]
  s_waitcnt vmcnt(12)
  v_mul_u32_u24 v16, v57, v44
  v_mul_u32_u24 v17, v57, v45
  v_mul_u32_u24 v18, v57, v46
  v_mul_u32_u24 v19, v57, v47
  s_nop 1
  v_mfma_f32_16x16x32_bf16 v[20:23], v[124:127], v[16:19], v[20:23]
  s_waitcnt vmcnt(11)
  v_mul_u32_u24 v12, v58, v44
  v_mul_u32_u24 v13, v58, v45
  v_mul_u32_u24 v14, v58, v46
  v_mul_u32_u24 v15, v58, v47
  s_nop 1
  v_mfma_f32_16x16x32_bf16 v[20:23], v[128:131], v[12:15], v[20:23]
  s_waitcnt vmcnt(10)
  v_mul_u32_u24 v16, v59, v44
  v_mul_u32_u24 v17, v59, v45
  v_mul_u32_u24 v18, v59, v46
  v_mul_u32_u24 v19, v59, v47
  s_nop 1
  v_mfma_f32_16x16x32_bf16 v[20:23], v[132:135], v[16:19], v[20:23]
  s_waitcnt vmcnt(9)
  v_mul_u32_u24 v12, v60, v44
  v_mul_u32_u24 v13, v60, v45
  v_mul_u32_u24 v14, v60, v46
  v_mul_u32_u24 v15, v60, v47
  s_nop 1
  v_mfma_f32_16x16x32_bf16 v[20:23], v[136:139], v[12:15], v[20:23]
  s_waitcnt vmcnt(8)
  v_mul_u32_u24 v16, v61, v44
  v_mul_u32_u24 v17, v61, v45
  v_mul_u32_u24 v18, v61, v46
  v_mul_u32_u24 v19, v61, v47
  s_nop 1
  v_mfma_f32_16x16x32_bf16 v[20:23], v[140:143], v[16:19], v[20:23]
  s_waitcnt vmcnt(7)
  v_mul_u32_u24 v12, v62, v44
  v_mul_u32_u24 v13, v62, v45
  v_mul_u32_u24 v14, v62, v46
  v_mul_u32_u24 v15, v62, v47
  s_nop 1
  v_mfma_f32_16x16x32_bf16 v[20:23], v[144:147], v[12:15], v[20:23]
  s_waitcnt vmcnt(6)
  v_mul_u32_u24 v16, v63, v44
  v_mul_u32_u24 v17, v63, v45
  v_mul_u32_u24 v18, v63, v46
  v_mul_u32_u24 v19, v63, v47
  s_nop 1
  v_mfma_f32_16x16x32_bf16 v[20:23], v[148:151], v[16:19], v[20:23]
  s_waitcnt vmcnt(5)
  v_mul_u32_u24 v12, v64, v44
  v_mul_u32_u24 v13, v64, v45
  v_mul_u32_u24 v14, v64, v46
  v_mul_u32_u24 v15, v64, v47
  s_nop 1
  v_mfma_f32_16x16x32_bf16 v[20:23], v[152:155], v[12:15], v[20:23]
  s_waitcnt vmcnt(4)
  v_mul_u32_u24 v16, v65, v44
  v_mul_u32_u24 v17, v65, v45
  v_mul_u32_u24 v18, v65, v46
  v_mul_u32_u24 v19, v65, v47
  s_nop 1
  v_mfma_f32_16x16x32_bf16 v[20:23], v[156:159], v[16:19], v[20:23]
  s_waitcnt vmcnt(3)
  v_mul_u32_u24 v12, v66, v44
  v_mul_u32_u24 v13, v66, v45
  v_mul_u32_u24 v14, v66, v46
  v_mul_u32_u24 v15, v66, v47
  s_nop 1
  v_mfma_f32_16x16x32_bf16 v[20:23], v[160:163], v[12:15], v[20:23]
  s_waitcnt vmcnt(2)
  v_mul_u32_u24 v16, v67, v44
  v_mul_u32_u24 v17, v67, v45
  v_mul_u32_u24 v18, v67, v46
  v_mul_u32_u24 v19, v67, v47
  s_nop 1
  v_mfma_f32_16x16x32_bf16 v[20:23], v[164:167], v[16:19], v[20:23]
  s_waitcnt vmcnt(1)
  v_mul_u32_u24 v12, v68, v44
  v_mul_u32_u24 v13, v68, v45
  v_mul_u32_u24 v14, v68, v46
  v_mul_u32_u24 v15, v68, v47
  s_nop 1
  v_mfma_f32_16x16x32_bf16 v[20:23], v[168:171], v[12:15], v[20:23]
  s_waitcnt vmcnt(0)
  v_mul_u32_u24 v16, v69, v44
  v_mul_u32_u24 v17, v69, v45
  v_mul_u32_u24 v18, v69, v46
  v_mul_u32_u24 v19, v69, v47
  s_nop 1
  v_mfma_f32_16x16x32_bf16 v[20:23], v[172:175], v[16:19], v[20:23]
  v_lshlrev_b32 v2, 4, v1
  s_lshl_b32 s20, s94, 3
  s_add_u32 s20, s20, s5
  s_lshl_b32 s20, s20, 10
  s_add_u32 s20, s20, 0x1c0000
  s_nop 2
  v_and_or_b32 v20, v20, s92, v48
  v_and_or_b32 v21, v21, s92, v48
  v_and_or_b32 v22, v22, s92, v48
  v_and_or_b32 v23, v23, s92, v48
  buffer_store_dwordx4 v[20:23], v2, s[16:19], s20 offen sc1
  s_nop 1
L_h_wo:
  s_lshl_b32 s20, s3, 5
  v_add_u32 v2, s20, v5
  v_mul_u32_u24 v2, 1280, v2
  v_lshl_add_u32 v2, v6, 4, v2
  s_mul_i32 s20, s4, 163840
  s_mov_b32 s21, 5120
  buffer_load_dwordx4 v[96:99], v2, s[40:43], s20 offen offset:0 nt
  buffer_load_dwordx4 v[100:103], v2, s[40:43], s20 offen offset:256 nt
  buffer_load_dwordx4 v[104:107], v2, s[40:43], s20 offen offset:512 nt
  s_waitcnt vmcnt(2)
  buffer_load_dwordx4 v[108:111], v2, s[40:43], s20 offen offset:768 nt
  s_waitcnt vmcnt(2)
  buffer_load_dwordx4 v[112:115], v2, s[40:43], s20 offen offset:1024 nt
  s_add_u32 s20, s20, s21
  s_waitcnt vmcnt(2)
  buffer_load_dwordx4 v[116:119], v2, s[40:43], s20 offen offset:0 nt
  s_waitcnt vmcnt(2)
  buffer_load_dwordx4 v[120:123], v2, s[40:43], s20 offen offset:256 nt
  s_waitcnt vmcnt(2)
  buffer_load_dwordx4 v[124:127], v2, s[40:43], s20 offen offset:512 nt
  s_waitcnt vmcnt(2)
  buffer_load_dwordx4 v[128:131], v2, s[40:43], s20 offen offset:768 nt
  s_waitcnt vmcnt(2)
  buffer_load_dwordx4 v[132:135], v2, s[40:43], s20 offen offset:1024 nt
  s_add_u32 s20, s20, s21
  s_waitcnt vmcnt(2)
  buffer_load_dwordx4 v[136:139], v2, s[40:43], s20 offen offset:0 nt
  s_waitcnt vmcnt(2)
  buffer_load_dwordx4 v[140:143], v2, s[40:43], s20 offen offset:256 nt
  s_waitcnt vmcnt(2)
  buffer_load_dwordx4 v[144:147], v2, s[40:43], s20 offen offset:512 nt
  s_waitcnt vmcnt(2)
  buffer_load_dwordx4 v[148:151], v2, s[40:43], s20 offen offset:768 nt
  s_waitcnt vmcnt(2)
  buffer_load_dwordx4 v[152:155], v2, s[40:43], s20 offen offset:1024 nt
  s_add_u32 s20, s20, s21
  s_waitcnt vmcnt(2)
  buffer_load_dwordx4 v[156:159], v2, s[40:43], s20 offen offset:0 nt
  s_waitcnt vmcnt(2)
  buffer_load_dwordx4 v[160:163], v2, s[40:43], s20 offen offset:256 nt
  s_waitcnt vmcnt(2)
  buffer_load_dwordx4 v[164:167], v2, s[40:43], s20 offen offset:512 nt
  s_waitcnt vmcnt(2)
  buffer_load_dwordx4 v[168:171], v2, s[40:43], s20 offen offset:768 nt
  s_waitcnt vmcnt(2)
  buffer_load_dwordx4 v[172:175], v2, s[40:43], s20 offen offset:1024 nt
  s_add_u32 s20, s20, s21
  s_waitcnt vmcnt(2)
  buffer_load_dwordx4 v[176:179], v2, s[40:43], s20 offen offset:0 nt
  s_waitcnt vmcnt(2)
  buffer_load_dwordx4 v[180:183], v2, s[40:43], s20 offen offset:256 nt
  s_waitcnt vmcnt(2)
  buffer_load_dwordx4 v[184:187], v2, s[40:43], s20 offen offset:512 nt
  s_waitcnt vmcnt(2)
  buffer_load_dwordx4 v[188:191], v2, s[40:43], s20 offen offset:768 nt
  s_waitcnt vmcnt(2)
  buffer_load_dwordx4 v[192:195], v2, s[40:43], s20 offen offset:1024 nt
  s_add_u32 s20, s20, s21
  s_waitcnt vmcnt(2)
  buffer_load_dwordx4 v[196:199], v2, s[40:43], s20 offen offset:0 nt
  s_waitcnt vmcnt(2)
  buffer_load_dwordx4 v[200:203], v2, s[40:43], s20 offen offset:256 nt
  s_waitcnt vmcnt(2)
  buffer_load_dwordx4 v[204:207], v2, s[40:43], s20 offen offset:512 nt
  s_waitcnt vmcnt(2)
  buffer_load_dwordx4 v[208:211], v2, s[40:43], s20 offen offset:768 nt
  s_waitcnt vmcnt(2)
  buffer_load_dwordx4 v[212:215], v2, s[40:43], s20 offen offset:1024 nt
  s_add_u32 s20, s20, s21
  s_waitcnt vmcnt(2)
  buffer_load_dwordx4 v[216:219], v2, s[40:43], s20 offen offset:0 nt
  s_waitcnt vmcnt(2)
  buffer_load_dwordx4 v[220:223], v2, s[40:43], s20 offen offset:256 nt
  s_waitcnt vmcnt(2)
  buffer_load_dwordx4 v[224:227], v2, s[40:43], s20 offen offset:512 nt
  s_waitcnt vmcnt(2)
  buffer_load_dwordx4 v[228:231], v2, s[40:43], s20 offen offset:768 nt
  s_waitcnt vmcnt(2)
  buffer_load_dwordx4 v[232:235], v2, s[40:43], s20 offen offset:1024 nt
  s_add_u32 s20, s20, s21
  s_waitcnt vmcnt(2)
  buffer_load_dwordx4 v[236:239], v2, s[40:43], s20 offen offset:0 nt
  s_waitcnt vmcnt(2)
  buffer_load_dwordx4 v[240:243], v2, s[40:43], s20 offen offset:256 nt
  s_waitcnt vmcnt(2)
  buffer_load_dwordx4 v[244:247], v2, s[40:43], s20 offen offset:512 nt
  s_waitcnt vmcnt(2)
  buffer_load_dwordx4 v[248:251], v2, s[40:43], s20 offen offset:768 nt
  s_waitcnt vmcnt(2)
  buffer_load_dwordx4 v[252:255], v2, s[40:43], s20 offen offset:1024 nt
  v_lshrrev_b32 v84, 3, v1
  s_lshl_b32 s23, s3, 3
  v_add_u32 v84, s23, v84
  v_mul_u32_u24 v85, 10240, v84
  v_and_b32 v86, 7, v1
  v_lshl_add_u32 v85, v86, 4, v85
  v_lshlrev_b32 v86, 6, v84
  s_cmp_ge_u32 s94, 27
  s_cbranch_scc1 L_h_cons
  s_cmp_lg_u32 s3, 2
  s_cbranch_scc1 L_h_b2
  v_lshrrev_b32 v2, 3, v1
  v_lshlrev_b32 v2, 10, v2
  v_and_b32 v3, 7, v1
  v_lshl_add_u32 v2, v3, 4, v2
  s_lshl_b32 s20, s94, 13
  s_add_u32 s20, s20, 0x1c0000
  s_lshr_b32 s21, s7, 1
  s_lshl_b32 s21, s21, 8
  s_add_u32 s20, s20, s21
  s_lshl_b32 s21, s6, 7
  s_add_u32 s20, s20, s21
  s_mov_b32 s56, 65536
L_h_gpoll:
  buffer_load_dwordx4 v[54:57], v2, s[16:19], s20 offen sc1
  buffer_load_dwordx4 v[58:61], v2, s[16:19], s20 offen offset:512 sc1
  s_waitcnt vmcnt(0)
  v_or3_b32 v80, v54, v55, v56
  v_and_b32 v81, v54, v55
  v_or3_b32 v80, v80, v57, v58
  v_or3_b32 v80, v80, v59, v60
  v_or_b32 v80, v80, v61
  v_and_b32 v81, v81, v56
  v_and_b32 v81, v81, v57
  v_and_b32 v81, v81, v58
  v_and_b32 v81, v81, v59
  v_and_b32 v81, v81, v60
  v_and_b32 v81, v81, v61
  v_xor_b32 v80, v80, v48
  v_xor_b32 v81, v81, v48
  v_or_b32 v80, v80, v81
  v_and_b32 v80, 0x3ff, v80
  v_cmp_ne_u32 vcc, 0, v80
  s_nop 1
  s_cbranch_vccz L_h_gdone
  s_sleep 16
  s_sub_u32 s56, s56, 1
  s_cmp_lg_u32 s56, 0
  s_cbranch_scc1 L_h_gpoll
L_h_gdone:
  s_bitcmp1_b32 s7, 0
  s_cselect_b64 s[58:59], -1, 0
  v_cndmask_b32_e64 v50, v54, v56, s[58:59]
  v_cndmask_b32_e64 v51, v55, v57, s[58:59]
  v_cndmask_b32_e64 v52, v58, v60, s[58:59]
  v_cndmask_b32_e64 v53, v59, v61, s[58:59]
  v_mul_u32_u24 v2, 1280, v5
  v_lshl_add_u32 v2, v6, 4, v2
  s_lshl_b32 s52, s94, 2
  s_add_u32 s52, s52, s7
  s_mul_i32 s20, s52, 20480
  s_mov_b32 s53, 0xffff0000
  v_permlane32_swap_b32 v50, v52
  v_permlane32_swap_b32 v51, v53
  v_add_f32 v50, v50, v52
  v_add_f32 v51, v51, v53
  s_nop 1
  v_permlane16_swap_b32 v50, v51
  v_add_f32 v50, v50, v51
  s_nop 1
  v_add_f32_dpp v50, v50, v50 row_ror:8 row_mask:0xf bank_mask:0xf
  v_lshl_add_u32 v3, v5, 3, v3
  v_lshlrev_b32 v3, 2, v3
  s_mov_b32 exec_lo, 0xff00ff
  s_mov_b32 exec_hi, 0xff00ff
  ds_write_b32 v3, v50 offset:4160
  s_mov_b64 exec, -1
  buffer_load_dwordx4 v[52:55], v2, s[32:35], s20 offen offset:0 nt
  buffer_load_dwordx4 v[56:59], v2, s[32:35], s20 offen offset:256 nt
  buffer_load_dwordx4 v[60:63], v2, s[32:35], s20 offen offset:512 nt
  buffer_load_dwordx4 v[64:67], v2, s[32:35], s20 offen offset:768 nt
  buffer_load_dwordx4 v[68:71], v2, s[32:35], s20 offen offset:1024 nt
  s_add_u32 s20, s20, 5120
  v_and_b32 v3, 3, v6
  v_lshl_add_u32 v3, v3, 2, v5
  v_lshlrev_b32 v3, 2, v3
  s_waitcnt lgkmcnt(0)
  ds_read_b32 v80, v3 offset:4160
  ds_read_b32 v81, v3 offset:4224
  s_waitcnt lgkmcnt(0)
  v_cvt_pk_bf16_f32 v80, v80, v81
  v_and_b32 v81, s53, v80
  v_lshlrev_b32 v80, 16, v80
  v_mul_f32 v82, 0xbfb8aa3b, v80
  v_exp_f32 v82, v82
  s_nop 0
  v_add_f32 v82, 1.0, v82
  v_rcp_f32 v82, v82
  s_nop 0
  v_mul_f32 v82, v80, v82
  v_cvt_pk_bf16_f32 v82, v82, v82
  v_and_b32 v82, s53, v82
  v_mul_f32 v82, v82, v81
  v_cvt_pk_bf16_f32 v82, v82, v82
  s_nop 1
  v_and_b32_dpp v12, v82, v8 row_newbcast:0 row_mask:0xf bank_mask:0xf
  v_and_b32_dpp v13, v82, v9 row_newbcast:0 row_mask:0xf bank_mask:0xf
  v_and_b32_dpp v14, v82, v10 row_newbcast:0 row_mask:0xf bank_mask:0xf
  v_and_b32_dpp v15, v82, v11 row_newbcast:0 row_mask:0xf bank_mask:0xf
  s_waitcnt vmcnt(0)
  s_nop 0
  v_mfma_f32_16x16x32_bf16 v[20:23], v[52:55], v[12:15], 0
  v_mfma_f32_16x16x32_bf16 v[24:27], v[56:59], v[12:15], 0
  v_mfma_f32_16x16x32_bf16 v[28:31], v[60:63], v[12:15], 0
  v_mfma_f32_16x16x32_bf16 v[32:35], v[64:67], v[12:15], 0
  v_mfma_f32_16x16x32_bf16 v[36:39], v[68:71], v[12:15], 0
  buffer_load_dwordx4 v[52:55], v2, s[32:35], s20 offen offset:0 nt
  buffer_load_dwordx4 v[56:59], v2, s[32:35], s20 offen offset:256 nt
  buffer_load_dwordx4 v[60:63], v2, s[32:35], s20 offen offset:512 nt
  buffer_load_dwordx4 v[64:67], v2, s[32:35], s20 offen offset:768 nt
  buffer_load_dwordx4 v[68:71], v2, s[32:35], s20 offen offset:1024 nt
  s_add_u32 s20, s20, 5120
  v_and_b32_dpp v16, v82, v8 row_newbcast:1 row_mask:0xf bank_mask:0xf
  v_and_b32_dpp v17, v82, v9 row_newbcast:1 row_mask:0xf bank_mask:0xf
  v_and_b32_dpp v18, v82, v10 row_newbcast:1 row_mask:0xf bank_mask:0xf
  v_and_b32_dpp v19, v82, v11 row_newbcast:1 row_mask:0xf bank_mask:0xf
  s_waitcnt vmcnt(0)
  s_nop 0
  v_mfma_f32_16x16x32_bf16 v[20:23], v[52:55], v[16:19], v[20:23]
  v_mfma_f32_16x16x32_bf16 v[24:27], v[56:59], v[16:19], v[24:27]
  v_mfma_f32_16x16x32_bf16 v[28:31], v[60:63], v[16:19], v[28:31]
  v_mfma_f32_16x16x32_bf16 v[32:35], v[64:67], v[16:19], v[32:35]
  v_mfma_f32_16x16x32_bf16 v[36:39], v[68:71], v[16:19], v[36:39]
  buffer_load_dwordx4 v[52:55], v2, s[32:35], s20 offen offset:0 nt
  buffer_load_dwordx4 v[56:59], v2, s[32:35], s20 offen offset:256 nt
  buffer_load_dwordx4 v[60:63], v2, s[32:35], s20 offen offset:512 nt
  buffer_load_dwordx4 v[64:67], v2, s[32:35], s20 offen offset:768 nt
  buffer_load_dwordx4 v[68:71], v2, s[32:35], s20 offen offset:1024 nt
  s_add_u32 s20, s20, 5120
  v_and_b32_dpp v12, v82, v8 row_newbcast:2 row_mask:0xf bank_mask:0xf
  v_and_b32_dpp v13, v82, v9 row_newbcast:2 row_mask:0xf bank_mask:0xf
  v_and_b32_dpp v14, v82, v10 row_newbcast:2 row_mask:0xf bank_mask:0xf
  v_and_b32_dpp v15, v82, v11 row_newbcast:2 row_mask:0xf bank_mask:0xf
  s_waitcnt vmcnt(0)
  s_nop 0
  v_mfma_f32_16x16x32_bf16 v[20:23], v[52:55], v[12:15], v[20:23]
  v_mfma_f32_16x16x32_bf16 v[24:27], v[56:59], v[12:15], v[24:27]
  v_mfma_f32_16x16x32_bf16 v[28:31], v[60:63], v[12:15], v[28:31]
  v_mfma_f32_16x16x32_bf16 v[32:35], v[64:67], v[12:15], v[32:35]
  v_mfma_f32_16x16x32_bf16 v[36:39], v[68:71], v[12:15], v[36:39]
  buffer_load_dwordx4 v[52:55], v2, s[32:35], s20 offen offset:0 nt
  buffer_load_dwordx4 v[56:59], v2, s[32:35], s20 offen offset:256 nt
  buffer_load_dwordx4 v[60:63], v2, s[32:35], s20 offen offset:512 nt
  buffer_load_dwordx4 v[64:67], v2, s[32:35], s20 offen offset:768 nt
  buffer_load_dwordx4 v[68:71], v2, s[32:35], s20 offen offset:1024 nt
  v_and_b32_dpp v16, v82, v8 row_newbcast:3 row_mask:0xf bank_mask:0xf
  v_and_b32_dpp v17, v82, v9 row_newbcast:3 row_mask:0xf bank_mask:0xf
  v_and_b32_dpp v18, v82, v10 row_newbcast:3 row_mask:0xf bank_mask:0xf
  v_and_b32_dpp v19, v82, v11 row_newbcast:3 row_mask:0xf bank_mask:0xf
  s_waitcnt vmcnt(0)
  s_nop 0
  v_mfma_f32_16x16x32_bf16 v[20:23], v[52:55], v[16:19], v[20:23]
  v_mfma_f32_16x16x32_bf16 v[24:27], v[56:59], v[16:19], v[24:27]
  v_mfma_f32_16x16x32_bf16 v[28:31], v[60:63], v[16:19], v[28:31]
  v_mfma_f32_16x16x32_bf16 v[32:35], v[64:67], v[16:19], v[32:35]
  v_mfma_f32_16x16x32_bf16 v[36:39], v[68:71], v[16:19], v[36:39]
  s_lshl_b32 s20, s6, 7
  s_add_u32 s20, s20, s52
  s_mul_i32 s20, s20, 2560
  s_add_u32 s20, s20, 0x100000
  v_and_or_b32 v20, v20, s92, v48
  v_and_or_b32 v21, v21, s92, v48
  v_and_or_b32 v22, v22, s92, v48
  v_and_or_b32 v23, v23, s92, v48
  v_and_or_b32 v24, v24, s92, v48
  v_and_or_b32 v25, v25, s92, v48
  v_and_or_b32 v26, v26, s92, v48
  v_and_or_b32 v27, v27, s92, v48
  v_and_or_b32 v28, v28, s92, v48
  v_and_or_b32 v29, v29, s92, v48
  v_and_or_b32 v30, v30, s92, v48
  v_and_or_b32 v31, v31, s92, v48
  v_and_or_b32 v32, v32, s92, v48
  v_and_or_b32 v33, v33, s92, v48
  v_and_or_b32 v34, v34, s92, v48
  v_and_or_b32 v35, v35, s92, v48
  v_and_or_b32 v36, v36, s92, v48
  v_and_or_b32 v37, v37, s92, v48
  v_and_or_b32 v38, v38, s92, v48
  v_and_or_b32 v39, v39, s92, v48
  s_mov_b32 exec_lo, 0xff00ff
  s_mov_b32 exec_hi, 0xff00ff
  buffer_store_dwordx4 v[20:23], v7, s[16:19], s20 offen offset:0 sc1
  buffer_store_dwordx4 v[24:27], v7, s[16:19], s20 offen offset:512 sc1
  buffer_store_dwordx4 v[28:31], v7, s[16:19], s20 offen offset:1024 sc1
  buffer_store_dwordx4 v[32:35], v7, s[16:19], s20 offen offset:1536 sc1
  buffer_store_dwordx4 v[36:39], v7, s[16:19], s20 offen offset:2048 sc1
  s_mov_b64 exec, -1
  s_branch L_h_b2
L_h_cons:
  s_sub_u32 s52, s94, 27
  s_lshl_b32 s52, s52, 3
  s_add_u32 s52, s52, s5
  s_cmp_ge_u32 s52, 20
  s_cselect_b32 s53, 1, 0
  s_mul_i32 s54, s53, 20
  s_sub_u32 s54, s52, s54
  v_lshlrev_b32 v2, 2, v1
  s_mul_i32 s20, s53, 1280
  buffer_load_dword v50, v2, s[68:71], s20 offen offset:0
  buffer_load_dword v58, v2, s[36:39], 0 offen offset:0
  buffer_load_dword v51, v2, s[68:71], s20 offen offset:256
  buffer_load_dword v59, v2, s[36:39], 0 offen offset:256
  buffer_load_dword v52, v2, s[68:71], s20 offen offset:512
  buffer_load_dword v60, v2, s[36:39], 0 offen offset:512
  buffer_load_dword v53, v2, s[68:71], s20 offen offset:768
  buffer_load_dword v61, v2, s[36:39], 0 offen offset:768
  buffer_load_dword v54, v2, s[68:71], s20 offen offset:1024
  buffer_load_dword v62, v2, s[36:39], 0 offen offset:1024
  s_mov_b32 s55, 0xffff0000
  s_waitcnt vmcnt(0)
  v_mov_b32 v78, 0
  v_lshlrev_b32 v80, 16, v50
  v_and_b32 v81, s55, v50
  v_lshlrev_b32 v82, 16, v58
  v_and_b32 v83, s55, v58
  v_mul_f32 v80, v80, v82
  v_mul_f32 v81, v81, v83
  v_cvt_pk_bf16_f32 v80, v80, v81
  v_and_b32 v81, s55, v80
  v_lshlrev_b32 v80, 16, v80
  v_add_f32 v78, v78, v80
  v_add_f32 v78, v78, v81
  v_lshlrev_b32 v80, 16, v51
  v_and_b32 v81, s55, v51
  v_lshlrev_b32 v82, 16, v59
  v_and_b32 v83, s55, v59
  v_mul_f32 v80, v80, v82
  v_mul_f32 v81, v81, v83
  v_cvt_pk_bf16_f32 v80, v80, v81
  v_and_b32 v81, s55, v80
  v_lshlrev_b32 v80, 16, v80
  v_add_f32 v78, v78, v80
  v_add_f32 v78, v78, v81
  v_lshlrev_b32 v80, 16, v52
  v_and_b32 v81, s55, v52
  v_lshlrev_b32 v82, 16, v60
  v_and_b32 v83, s55, v60
  v_mul_f32 v80, v80, v82
  v_mul_f32 v81, v81, v83
  v_cvt_pk_bf16_f32 v80, v80, v81
  v_and_b32 v81, s55, v80
  v_lshlrev_b32 v80, 16, v80
  v_add_f32 v78, v78, v80
  v_add_f32 v78, v78, v81
  v_lshlrev_b32 v80, 16, v53
  v_and_b32 v81, s55, v53
  v_lshlrev_b32 v82, 16, v61
  v_and_b32 v83, s55, v61
  v_mul_f32 v80, v80, v82
  v_mul_f32 v81, v81, v83
  v_cvt_pk_bf16_f32 v80, v80, v81
  v_and_b32 v81, s55, v80
  v_lshlrev_b32 v80, 16, v80
  v_add_f32 v78, v78, v80
  v_add_f32 v78, v78, v81
  v_lshlrev_b32 v80, 16, v54
  v_and_b32 v81, s55, v54
  v_lshlrev_b32 v82, 16, v62
  v_and_b32 v83, s55, v62
  v_mul_f32 v80, v80, v82
  v_mul_f32 v81, v81, v83
  v_cvt_pk_bf16_f32 v80, v80, v81
  v_and_b32 v81, s55, v80
  v_lshlrev_b32 v80, 16, v80
  v_add_f32 v78, v78, v80
  v_add_f32 v78, v78, v81
  s_nop 1
  v_add_f32_dpp v78, v78, v78 quad_perm:[1,0,3,2] row_mask:0xf bank_mask:0xf
  s_nop 1
  v_add_f32_dpp v78, v78, v78 quad_perm:[2,3,0,1] row_mask:0xf bank_mask:0xf
  s_nop 1
  v_add_f32_dpp v78, v78, v78 row_ror:4 row_mask:0xf bank_mask:0xf
  s_nop 1
  v_add_f32_dpp v78, v78, v78 row_ror:8 row_mask:0xf bank_mask:0xf
  v_mov_b32 v80, v78
  s_nop 1
  v_permlane16_swap_b32 v80, v78
  v_add_f32 v78, v78, v80
  v_mov_b32 v80, v78
  s_nop 1
  v_permlane32_swap_b32 v80, v78
  v_add_f32 v78, v78, v80
  v_cvt_pk_bf16_f32 v78, v78, v78
  v_and_b32 v78, s55, v78
  v_mul_f32 v80, 0xbfb8aa3b, v78
  v_exp_f32 v80, v80
  s_nop 0
  v_add_f32 v80, 1.0, v80
  v_rcp_f32 v80, v80
  s_nop 0
  v_cvt_pk_bf16_f32 v80, v80, v80
  v_and_b32 v78, s55, v80
  v_sub_f32 v80, 1.0, v78
  v_cvt_pk_bf16_f32 v80, v80, v80
  v_and_b32 v79, s55, v80
  s_mul_i32 s58, s53, 327680
  s_lshl_b32 s20, s54, 7
  s_add_u32 s58, s58, s20
  s_add_u32 s60, s58, 0
  s_add_u32 s61, s58, 2560
  s_add_u32 s62, s58, 5120
  s_add_u32 s63, s58, 7680
  s_add_u32 s64, s60, 0x100000
  s_add_u32 s65, s61, 0x100000
  s_add_u32 s66, s62, 0x100000
  s_add_u32 s67, s63, 0x100000
  s_lshl_b32 s59, s53, 11
  s_add_u32 s59, s59, 0xa0000
L_h_b2:
  v_and_b32 v2, 1, v6
  v_lshl_add_u32 v2, v2, 2, v5
  v_lshlrev_b32 v2, 4, v2
  v_bfe_u32 v3, v6, 1, 2
  v_lshl_add_u32 v2, v3, 2, v2
  s_lshl_b32 s20, s3, 7
  v_add_u32 v2, s20, v2
  v_mov_b32 v3, 0
  s_mul_i32 s20, s3, 2560
  v_add_u32 v7, s20, v7
  s_waitcnt vmcnt(0)
  s_barrier
  ds_read_b128 v[80:83], v3 offset:4096
  ds_read_b128 v[88:91], v3 offset:4112
  ds_read_b32 v92, v2 offset:2048
  ds_read_b32 v93, v2 offset:2560
  ds_read_b32 v94, v2 offset:3072
  ds_read_b32 v95, v2 offset:3584
  s_cmp_lt_u32 s94, 27
  s_cbranch_scc1 L_h_nocnt
  buffer_load_dwordx4 v[50:53], v85, s[16:19], s64 offen sc1
  buffer_load_dwordx4 v[54:57], v85, s[16:19], s65 offen sc1
  buffer_load_dwordx4 v[58:61], v85, s[16:19], s66 offen sc1
  buffer_load_dwordx4 v[62:65], v85, s[16:19], s67 offen sc1
L_h_nocnt:
  s_waitcnt lgkmcnt(0)
  v_max_f32 v4, v80, v82
  v_max3_f32 v4, v4, v88, v90
  v_sub_f32 v80, v80, v4
  v_exp_f32 v80, v80
  v_sub_f32 v82, v82, v4
  v_exp_f32 v82, v82
  v_sub_f32 v88, v88, v4
  v_exp_f32 v88, v88
  v_sub_f32 v90, v90, v4
  v_exp_f32 v90, v90
  v_mul_f32 v4, v80, v92
  v_fma_f32 v4, v82, v93, v4
  v_fma_f32 v4, v88, v94, v4
  v_fma_f32 v4, v90, v95, v4
  v_cvt_pk_bf16_f32 v4, v4, v4
  s_nop 1
  v_and_b32_dpp v12, v4, v8 row_newbcast:0 row_mask:0xf bank_mask:0xf
  v_and_b32_dpp v13, v4, v9 row_newbcast:0 row_mask:0xf bank_mask:0xf
  v_and_b32_dpp v14, v4, v10 row_newbcast:0 row_mask:0xf bank_mask:0xf
  v_and_b32_dpp v15, v4, v11 row_newbcast:0 row_mask:0xf bank_mask:0xf
  s_nop 1
  v_mfma_f32_16x16x32_bf16 v[20:23], v[96:99], v[12:15], 0
  v_mfma_f32_16x16x32_bf16 v[24:27], v[100:103], v[12:15], 0
  v_mfma_f32_16x16x32_bf16 v[28:31], v[104:107], v[12:15], 0
  v_mfma_f32_16x16x32_bf16 v[32:35], v[108:111], v[12:15], 0
  v_mfma_f32_16x16x32_bf16 v[36:39], v[112:115], v[12:15], 0
  v_and_b32_dpp v16, v4, v8 row_newbcast:1 row_mask:0xf bank_mask:0xf
  v_and_b32_dpp v17, v4, v9 row_newbcast:1 row_mask:0xf bank_mask:0xf
  v_and_b32_dpp v18, v4, v10 row_newbcast:1 row_mask:0xf bank_mask:0xf
  v_and_b32_dpp v19, v4, v11 row_newbcast:1 row_mask:0xf bank_mask:0xf
  s_nop 1
  v_mfma_f32_16x16x32_bf16 v[20:23], v[116:119], v[16:19], v[20:23]
  v_mfma_f32_16x16x32_bf16 v[24:27], v[120:123], v[16:19], v[24:27]
  v_mfma_f32_16x16x32_bf16 v[28:31], v[124:127], v[16:19], v[28:31]
  v_mfma_f32_16x16x32_bf16 v[32:35], v[128:131], v[16:19], v[32:35]
  v_mfma_f32_16x16x32_bf16 v[36:39], v[132:135], v[16:19], v[36:39]
  v_and_b32_dpp v12, v4, v8 row_newbcast:2 row_mask:0xf bank_mask:0xf
  v_and_b32_dpp v13, v4, v9 row_newbcast:2 row_mask:0xf bank_mask:0xf
  v_and_b32_dpp v14, v4, v10 row_newbcast:2 row_mask:0xf bank_mask:0xf
  v_and_b32_dpp v15, v4, v11 row_newbcast:2 row_mask:0xf bank_mask:0xf
  s_nop 1
  v_mfma_f32_16x16x32_bf16 v[20:23], v[136:139], v[12:15], v[20:23]
  v_mfma_f32_16x16x32_bf16 v[24:27], v[140:143], v[12:15], v[24:27]
  v_mfma_f32_16x16x32_bf16 v[28:31], v[144:147], v[12:15], v[28:31]
  v_mfma_f32_16x16x32_bf16 v[32:35], v[148:151], v[12:15], v[32:35]
  v_mfma_f32_16x16x32_bf16 v[36:39], v[152:155], v[12:15], v[36:39]
  v_and_b32_dpp v16, v4, v8 row_newbcast:3 row_mask:0xf bank_mask:0xf
  v_and_b32_dpp v17, v4, v9 row_newbcast:3 row_mask:0xf bank_mask:0xf
  v_and_b32_dpp v18, v4, v10 row_newbcast:3 row_mask:0xf bank_mask:0xf
  v_and_b32_dpp v19, v4, v11 row_newbcast:3 row_mask:0xf bank_mask:0xf
  s_nop 1
  v_mfma_f32_16x16x32_bf16 v[20:23], v[156:159], v[16:19], v[20:23]
  v_mfma_f32_16x16x32_bf16 v[24:27], v[160:163], v[16:19], v[24:27]
  v_mfma_f32_16x16x32_bf16 v[28:31], v[164:167], v[16:19], v[28:31]
  v_mfma_f32_16x16x32_bf16 v[32:35], v[168:171], v[16:19], v[32:35]
  v_mfma_f32_16x16x32_bf16 v[36:39], v[172:175], v[16:19], v[36:39]
  v_and_b32_dpp v12, v4, v8 row_newbcast:4 row_mask:0xf bank_mask:0xf
  v_and_b32_dpp v13, v4, v9 row_newbcast:4 row_mask:0xf bank_mask:0xf
  v_and_b32_dpp v14, v4, v10 row_newbcast:4 row_mask:0xf bank_mask:0xf
  v_and_b32_dpp v15, v4, v11 row_newbcast:4 row_mask:0xf bank_mask:0xf
  s_nop 1
  v_mfma_f32_16x16x32_bf16 v[20:23], v[176:179], v[12:15], v[20:23]
  v_mfma_f32_16x16x32_bf16 v[24:27], v[180:183], v[12:15], v[24:27]
  v_mfma_f32_16x16x32_bf16 v[28:31], v[184:187], v[12:15], v[28:31]
  v_mfma_f32_16x16x32_bf16 v[32:35], v[188:191], v[12:15], v[32:35]
  v_mfma_f32_16x16x32_bf16 v[36:39], v[192:195], v[12:15], v[36:39]
  v_and_b32_dpp v16, v4, v8 row_newbcast:5 row_mask:0xf bank_mask:0xf
  v_and_b32_dpp v17, v4, v9 row_newbcast:5 row_mask:0xf bank_mask:0xf
  v_and_b32_dpp v18, v4, v10 row_newbcast:5 row_mask:0xf bank_mask:0xf
  v_and_b32_dpp v19, v4, v11 row_newbcast:5 row_mask:0xf bank_mask:0xf
  s_nop 1
  v_mfma_f32_16x16x32_bf16 v[20:23], v[196:199], v[16:19], v[20:23]
  v_mfma_f32_16x16x32_bf16 v[24:27], v[200:203], v[16:19], v[24:27]
  v_mfma_f32_16x16x32_bf16 v[28:31], v[204:207], v[16:19], v[28:31]
  v_mfma_f32_16x16x32_bf16 v[32:35], v[208:211], v[16:19], v[32:35]
  v_mfma_f32_16x16x32_bf16 v[36:39], v[212:215], v[16:19], v[36:39]
  v_and_b32_dpp v12, v4, v8 row_newbcast:6 row_mask:0xf bank_mask:0xf
  v_and_b32_dpp v13, v4, v9 row_newbcast:6 row_mask:0xf bank_mask:0xf
  v_and_b32_dpp v14, v4, v10 row_newbcast:6 row_mask:0xf bank_mask:0xf
  v_and_b32_dpp v15, v4, v11 row_newbcast:6 row_mask:0xf bank_mask:0xf
  s_nop 1
  v_mfma_f32_16x16x32_bf16 v[20:23], v[216:219], v[12:15], v[20:23]
  v_mfma_f32_16x16x32_bf16 v[24:27], v[220:223], v[12:15], v[24:27]
  v_mfma_f32_16x16x32_bf16 v[28:31], v[224:227], v[12:15], v[28:31]
  v_mfma_f32_16x16x32_bf16 v[32:35], v[228:231], v[12:15], v[32:35]
  v_mfma_f32_16x16x32_bf16 v[36:39], v[232:235], v[12:15], v[36:39]
  v_and_b32_dpp v16, v4, v8 row_newbcast:7 row_mask:0xf bank_mask:0xf
  v_and_b32_dpp v17, v4, v9 row_newbcast:7 row_mask:0xf bank_mask:0xf
  v_and_b32_dpp v18, v4, v10 row_newbcast:7 row_mask:0xf bank_mask:0xf
  v_and_b32_dpp v19, v4, v11 row_newbcast:7 row_mask:0xf bank_mask:0xf
  s_nop 1
  v_mfma_f32_16x16x32_bf16 v[20:23], v[236:239], v[16:19], v[20:23]
  v_mfma_f32_16x16x32_bf16 v[24:27], v[240:243], v[16:19], v[24:27]
  v_mfma_f32_16x16x32_bf16 v[28:31], v[244:247], v[16:19], v[28:31]
  v_mfma_f32_16x16x32_bf16 v[32:35], v[248:251], v[16:19], v[32:35]
  v_mfma_f32_16x16x32_bf16 v[36:39], v[252:255], v[16:19], v[36:39]
  s_mov_b32 exec_lo, 0xff00ff
  s_mov_b32 exec_hi, 0xff00ff
  s_nop 1
  ds_write_b128 v7, v[20:23] offset:5120
  ds_write_b128 v7, v[24:27] offset:5632
  ds_write_b128 v7, v[28:31] offset:6144
  ds_write_b128 v7, v[32:35] offset:6656
  ds_write_b128 v7, v[36:39] offset:7168
  s_mov_b64 exec, -1
  s_waitcnt lgkmcnt(0)
  s_barrier
  s_cmp_lt_u32 s94, 27
  s_cbranch_scc1 L_h_done
  s_mov_b32 s56, 65536
L_h_yf:
  s_waitcnt vmcnt(0)
  v_or3_b32 v80, v50, v51, v52
  v_and_b32 v81, v50, v51
  v_or3_b32 v80, v80, v53, v54
  v_or3_b32 v80, v80, v55, v56
  v_or3_b32 v80, v80, v57, v58
  v_or3_b32 v80, v80, v59, v60
  v_or3_b32 v80, v80, v61, v62
  v_or3_b32 v80, v80, v63, v64
  v_or_b32 v80, v80, v65
  v_and_b32 v81, v81, v52
  v_and_b32 v81, v81, v53
  v_and_b32 v81, v81, v54
  v_and_b32 v81, v81, v55
  v_and_b32 v81, v81, v56
  v_and_b32 v81, v81, v57
  v_and_b32 v81, v81, v58
  v_and_b32 v81, v81, v59
  v_and_b32 v81, v81, v60
  v_and_b32 v81, v81, v61
  v_and_b32 v81, v81, v62
  v_and_b32 v81, v81, v63
  v_and_b32 v81, v81, v64
  v_and_b32 v81, v81, v65
  v_xor_b32 v80, v80, v48
  v_xor_b32 v81, v81, v48
  v_or_b32 v80, v80, v81
  v_and_b32 v80, 0x3ff, v80
  v_cmp_gt_u32 vcc, 27, v84
  s_nop 1
  v_cndmask_b32 v80, 0, v80, vcc
  v_cmp_ne_u32 vcc, 0, v80
  s_nop 1
  s_cbranch_vccz L_h_yfok
  s_sleep 4
  buffer_load_dwordx4 v[50:53], v85, s[16:19], s64 offen sc1
  buffer_load_dwordx4 v[54:57], v85, s[16:19], s65 offen sc1
  buffer_load_dwordx4 v[58:61], v85, s[16:19], s66 offen sc1
  buffer_load_dwordx4 v[62:65], v85, s[16:19], s67 offen sc1
  s_sub_u32 s56, s56, 1
  s_cmp_lg_u32 s56, 0
  s_cbranch_scc1 L_h_yf
  s_waitcnt vmcnt(0)
L_h_yfok:
  s_mov_b32 s56, 65536
  buffer_load_dwordx4 v[112:115], v86, s[16:19], s59 offen offset:0 sc1
  buffer_load_dwordx4 v[116:119], v86, s[16:19], s59 offen offset:16 sc1
  buffer_load_dwordx4 v[120:123], v86, s[16:19], s59 offen offset:32 sc1
  buffer_load_dwordx4 v[124:127], v86, s[16:19], s59 offen offset:48 sc1
  v_cmp_gt_u32 vcc, 27, v84
  v_add_f32 v50, v50, v54
  v_add_f32 v58, v58, v62
  v_add_f32 v51, v51, v55
  v_add_f32 v59, v59, v63
  v_add_f32 v52, v52, v56
  v_add_f32 v60, v60, v64
  v_add_f32 v53, v53, v57
  v_add_f32 v61, v61, v65
  v_add_f32 v50, v50, v58
  v_add_f32 v51, v51, v59
  v_add_f32 v52, v52, v60
  v_add_f32 v53, v53, v61
  v_cndmask_b32 v74, 0, v50, vcc
  v_cndmask_b32 v75, 0, v51, vcc
  v_cndmask_b32 v76, 0, v52, vcc
  v_cndmask_b32 v77, 0, v53, vcc
  v_mul_f32 v74, v79, v74
  v_mul_f32 v75, v79, v75
  v_mul_f32 v76, v79, v76
  v_mul_f32 v77, v79, v77
  s_branch L_h_mlw
L_h_ml:
  buffer_load_dwordx4 v[112:115], v86, s[16:19], s59 offen offset:0 sc1
  buffer_load_dwordx4 v[116:119], v86, s[16:19], s59 offen offset:16 sc1
  buffer_load_dwordx4 v[120:123], v86, s[16:19], s59 offen offset:32 sc1
  buffer_load_dwordx4 v[124:127], v86, s[16:19], s59 offen offset:48 sc1
L_h_mlw:
  s_waitcnt vmcnt(0)
  v_xor_b32 v113, s95, v113
  v_xor_b32 v115, s95, v115
  v_xor_b32 v117, s95, v117
  v_xor_b32 v119, s95, v119
  v_xor_b32 v121, s95, v121
  v_xor_b32 v123, s95, v123
  v_xor_b32 v125, s95, v125
  v_xor_b32 v127, s95, v127
  v_or3_b32 v82, v113, v115, v117
  v_or3_b32 v82, v82, v119, v121
  v_or3_b32 v82, v82, v123, v125
  v_or_b32 v82, v82, v127
  v_cmp_ne_u32 vcc, 0, v82
  s_nop 1
  s_cbranch_vccz L_h_mlok
  s_sleep 1
  s_sub_u32 s56, s56, 1
  s_cmp_lg_u32 s56, 0
  s_cbranch_scc1 L_h_ml
L_h_mlok:
  buffer_load_dwordx4 v[96:99], v85, s[16:19], s60 offen sc1
  buffer_load_dwordx4 v[100:103], v85, s[16:19], s61 offen sc1
  buffer_load_dwordx4 v[104:107], v85, s[16:19], s62 offen sc1
  buffer_load_dwordx4 v[108:111], v85, s[16:19], s63 offen sc1
  v_max_f32 v80, v112, v116
  v_max3_f32 v80, v80, v120, v124
  v_sub_f32 v112, v112, v80
  v_exp_f32 v112, v112
  v_sub_f32 v116, v116, v80
  v_exp_f32 v116, v116
  v_sub_f32 v120, v120, v80
  v_exp_f32 v120, v120
  v_sub_f32 v124, v124, v80
  v_exp_f32 v124, v124
  v_mul_f32 v80, v112, v114
  v_fma_f32 v80, v116, v118, v80
  v_fma_f32 v80, v120, v122, v80
  v_fma_f32 v80, v124, v126, v80
  v_rcp_f32 v80, v80
  s_nop 0
  v_mul_f32 v80, v78, v80
  v_mul_f32 v112, v112, v80
  v_mul_f32 v116, v116, v80
  v_mul_f32 v120, v120, v80
  v_mul_f32 v124, v124, v80
  v_and_b32 v87, 7, v1
  v_lshlrev_b32 v87, 2, v87
  v_bfe_u32 v3, v1, 4, 1
  v_lshl_add_u32 v87, v3, 6, v87
  v_lshrrev_b32 v3, 5, v1
  v_lshl_add_u32 v87, v3, 5, v87
  s_lshl_b32 s20, s3, 7
  v_add_u32 v87, s20, v87
  v_lshlrev_b32 v88, 2, v1
  v_lshlrev_b32 v89, 1, v1
  s_mul_i32 s20, s53, 1280
  s_lshl_b32 s21, s54, 6
  s_add_u32 s57, s20, s21
  s_mov_b32 s56, 65536
L_h_ypoll:
  buffer_load_dwordx4 v[128:131], v85, s[16:19], s60 offen sc1
  buffer_load_dwordx4 v[132:135], v85, s[16:19], s61 offen sc1
  buffer_load_dwordx4 v[136:139], v85, s[16:19], s62 offen sc1
  buffer_load_dwordx4 v[140:143], v85, s[16:19], s63 offen sc1
  s_waitcnt vmcnt(4)
  v_or3_b32 v80, v96, v97, v98
  v_and_b32 v81, v96, v97
  v_or3_b32 v80, v80, v99, v100
  v_or3_b32 v80, v80, v101, v102
  v_or3_b32 v80, v80, v103, v104
  v_or3_b32 v80, v80, v105, v106
  v_or3_b32 v80, v80, v107, v108
  v_or3_b32 v80, v80, v109, v110
  v_or_b32 v80, v80, v111
  v_and_b32 v81, v81, v98
  v_and_b32 v81, v81, v99
  v_and_b32 v81, v81, v100
  v_and_b32 v81, v81, v101
  v_and_b32 v81, v81, v102
  v_and_b32 v81, v81, v103
  v_and_b32 v81, v81, v104
  v_and_b32 v81, v81, v105
  v_and_b32 v81, v81, v106
  v_and_b32 v81, v81, v107
  v_and_b32 v81, v81, v108
  v_and_b32 v81, v81, v109
  v_and_b32 v81, v81, v110
  v_and_b32 v81, v81, v111
  v_xor_b32 v80, v80, v48
  v_xor_b32 v81, v81, v48
  v_or_b32 v80, v80, v81
  v_and_b32 v80, 0x3ff, v80
  v_cmp_ne_u32 vcc, 0, v80
  s_nop 1
  s_cbranch_vccz L_h_useA
  buffer_load_dwordx4 v[96:99], v85, s[16:19], s60 offen sc1
  buffer_load_dwordx4 v[100:103], v85, s[16:19], s61 offen sc1
  buffer_load_dwordx4 v[104:107], v85, s[16:19], s62 offen sc1
  buffer_load_dwordx4 v[108:111], v85, s[16:19], s63 offen sc1
  s_waitcnt vmcnt(4)
  v_or3_b32 v80, v128, v129, v130
  v_and_b32 v81, v128, v129
  v_or3_b32 v80, v80, v131, v132
  v_or3_b32 v80, v80, v133, v134
  v_or3_b32 v80, v80, v135, v136
  v_or3_b32 v80, v80, v137, v138
  v_or3_b32 v80, v80, v139, v140
  v_or3_b32 v80, v80, v141, v142
  v_or_b32 v80, v80, v143
  v_and_b32 v81, v81, v130
  v_and_b32 v81, v81, v131
  v_and_b32 v81, v81, v132
  v_and_b32 v81, v81, v133
  v_and_b32 v81, v81, v134
  v_and_b32 v81, v81, v135
  v_and_b32 v81, v81, v136
  v_and_b32 v81, v81, v137
  v_and_b32 v81, v81, v138
  v_and_b32 v81, v81, v139
  v_and_b32 v81, v81, v140
  v_and_b32 v81, v81, v141
  v_and_b32 v81, v81, v142
  v_and_b32 v81, v81, v143
  v_xor_b32 v80, v80, v48
  v_xor_b32 v81, v81, v48
  v_or_b32 v80, v80, v81
  v_and_b32 v80, 0x3ff, v80
  v_cmp_ne_u32 vcc, 0, v80
  s_nop 1
  s_cbranch_vccz L_h_useB
  s_sub_u32 s56, s56, 1
  s_cmp_lg_u32 s56, 0
  s_cbranch_scc1 L_h_ypoll
L_h_useB:
  v_fma_f32 v74, v112, v128, v74
  v_fma_f32 v74, v116, v132, v74
  v_fma_f32 v74, v120, v136, v74
  v_fma_f32 v74, v124, v140, v74
  v_fma_f32 v75, v112, v129, v75
  v_fma_f32 v75, v116, v133, v75
  v_fma_f32 v75, v120, v137, v75
  v_fma_f32 v75, v124, v141, v75
  v_fma_f32 v76, v112, v130, v76
  v_fma_f32 v76, v116, v134, v76
  v_fma_f32 v76, v120, v138, v76
  v_fma_f32 v76, v124, v142, v76
  v_fma_f32 v77, v112, v131, v77
  v_fma_f32 v77, v116, v135, v77
  v_fma_f32 v77, v120, v139, v77
  v_fma_f32 v77, v124, v143, v77
  s_nop 1
  s_branch L_h_ready
L_h_useA:
  v_fma_f32 v74, v112, v96, v74
  v_fma_f32 v74, v116, v100, v74
  v_fma_f32 v74, v120, v104, v74
  v_fma_f32 v74, v124, v108, v74
  v_fma_f32 v75, v112, v97, v75
  v_fma_f32 v75, v116, v101, v75
  v_fma_f32 v75, v120, v105, v75
  v_fma_f32 v75, v124, v109, v75
  v_fma_f32 v76, v112, v98, v76
  v_fma_f32 v76, v116, v102, v76
  v_fma_f32 v76, v120, v106, v76
  v_fma_f32 v76, v124, v110, v76
  v_fma_f32 v77, v112, v99, v77
  v_fma_f32 v77, v116, v103, v77
  v_fma_f32 v77, v120, v107, v77
  v_fma_f32 v77, v124, v111, v77
  s_nop 1
L_h_ready:
  v_permlane32_swap_b32 v74, v75
  v_permlane32_swap_b32 v76, v77
  v_add_f32 v74, v74, v75
  v_add_f32 v76, v76, v77
  s_nop 1
  v_permlane16_swap_b32 v74, v76
  v_add_f32 v74, v74, v76
  s_nop 1
  v_add_f32_dpp v74, v74, v74 row_ror:8 row_mask:0xf bank_mask:0xf
  s_mov_b32 exec_lo, 0xff00ff
  s_mov_b32 exec_hi, 0xff00ff
  ds_write_b32 v87, v74 offset:4352
  s_mov_b64 exec, -1
  s_waitcnt lgkmcnt(0)
  s_barrier
  s_cmp_lg_u32 s3, 0
  s_cbranch_scc1 L_h_done
  s_mov_b32 exec_lo, -1
  s_mov_b32 exec_hi, 0
  ds_read_b32 v80, v88 offset:4352
  ds_read_b32 v81, v88 offset:4480
  ds_read_b32 v82, v88 offset:4608
  ds_read_b32 v83, v88 offset:4736
  s_waitcnt lgkmcnt(0)
  v_add_f32 v80, v80, v81
  v_add_f32 v82, v82, v83
  v_add_f32 v80, v80, v82
  v_cvt_pk_bf16_f32 v80, v80, v80
  buffer_store_short v80, v89, s[44:47], s57 offen
  s_mov_b64 exec, -1
L_h_done:
L_end:
  s_endpgm
L_stream2:
  v_and_b32 v6, 15, v1
  v_and_b32 v4, 1, v6
  v_lshlrev_b32 v4, 4, v4
  v_mov_b32 v7, 0xffff
  v_lshlrev_b32 v7, v4, v7
  v_lshrrev_b32 v4, 1, v6
  v_cmp_eq_u32 vcc, 0, v4
  s_nop 1
  v_cndmask_b32 v8, 0, v7, vcc
  v_cmp_eq_u32 vcc, 1, v4
  s_nop 1
  v_cndmask_b32 v9, 0, v7, vcc
  v_cmp_eq_u32 vcc, 2, v4
  s_nop 1
  v_cndmask_b32 v10, 0, v7, vcc
  v_cmp_eq_u32 vcc, 3, v4
  s_nop 1
  v_cndmask_b32 v11, 0, v7, vcc
  s_mov_b32 s24, 0x3fb8aa3b
  s_mov_b32 s25, 0x3db504f3
  s_lshl_b32 s26, s3, 13
  s_add_u32 s26, s26, 15360
  v_lshlrev_b32 v7, 2, v1
  v_add_u32 v36, s26, v7
  v_bfe_u32 v7, v1, 2, 2
  v_lshlrev_b32 v7, 6, v7
  v_lshl_add_u32 v7, v5, 4, v7
  v_and_b32 v4, 3, v1
  v_lshl_add_u32 v7, v4, 2, v7
  v_add_u32 v37, s26, v7
  v_lshlrev_b32 v4, 5, v4
  v_lshl_add_u32 v4, v5, 7, v4
  s_waitcnt vmcnt(4)
  buffer_load_dwordx4 v[96:99], v2, s[8:11], s20 offen offset:0 nt
  s_waitcnt vmcnt(4)
  buffer_load_dwordx4 v[100:103], v2, s[8:11], s20 offen offset:1024 nt
  s_waitcnt vmcnt(4)
  buffer_load_dwordx4 v[104:107], v2, s[8:11], s20 offen offset:2048 nt
  s_waitcnt vmcnt(4)
  buffer_load_dwordx4 v[108:111], v2, s[8:11], s20 offen offset:3072 nt
  s_add_u32 s30, s30, s21
  s_add_u32 s31, s31, 0x80000
  s_and_b32 s31, s31, 0x180000
  s_add_u32 s20, s30, s31
  s_waitcnt vmcnt(4)
  buffer_load_dwordx4 v[112:115], v2, s[8:11], s20 offen offset:0 nt
  s_waitcnt vmcnt(4)
  buffer_load_dwordx4 v[116:119], v2, s[8:11], s20 offen offset:1024 nt
  s_waitcnt vmcnt(4)
  buffer_load_dwordx4 v[120:123], v2, s[8:11], s20 offen offset:2048 nt
  s_waitcnt vmcnt(4)
  buffer_load_dwordx4 v[124:127], v2, s[8:11], s20 offen offset:3072 nt
  s_add_u32 s30, s30, s21
  s_add_u32 s31, s31, 0x80000
  s_and_b32 s31, s31, 0x180000
  s_add_u32 s20, s30, s31
  s_waitcnt vmcnt(4)
  buffer_load_dwordx4 v[128:131], v2, s[8:11], s20 offen offset:0 nt
  s_waitcnt vmcnt(4)
  buffer_load_dwordx4 v[132:135], v2, s[8:11], s20 offen offset:1024 nt
  s_waitcnt vmcnt(4)
  buffer_load_dwordx4 v[136:139], v2, s[8:11], s20 offen offset:2048 nt
  s_waitcnt vmcnt(4)
  buffer_load_dwordx4 v[140:143], v2, s[8:11], s20 offen offset:3072 nt
  s_add_u32 s30, s30, s21
  s_add_u32 s31, s31, 0x80000
  s_and_b32 s31, s31, 0x180000
  s_add_u32 s20, s30, s31
  s_waitcnt vmcnt(4)
  buffer_load_dwordx4 v[144:147], v2, s[8:11], s20 offen offset:0 nt
  s_waitcnt vmcnt(4)
  buffer_load_dwordx4 v[148:151], v2, s[8:11], s20 offen offset:1024 nt
  s_waitcnt vmcnt(4)
  buffer_load_dwordx4 v[152:155], v2, s[8:11], s20 offen offset:2048 nt
  s_waitcnt vmcnt(4)
  buffer_load_dwordx4 v[156:159], v2, s[8:11], s20 offen offset:3072 nt
  s_add_u32 s30, s30, s21
  s_add_u32 s31, s31, 0x80000
  s_and_b32 s31, s31, 0x180000
  s_add_u32 s20, s30, s31
  s_waitcnt vmcnt(4)
  buffer_load_dwordx4 v[160:163], v2, s[8:11], s20 offen offset:0 nt
  s_waitcnt vmcnt(4)
  buffer_load_dwordx4 v[164:167], v2, s[8:11], s20 offen offset:1024 nt
  s_waitcnt vmcnt(4)
  buffer_load_dwordx4 v[168:171], v2, s[8:11], s20 offen offset:2048 nt
  s_waitcnt vmcnt(4)
  buffer_load_dwordx4 v[172:175], v2, s[8:11], s20 offen offset:3072 nt
  s_add_u32 s30, s30, s21
  s_add_u32 s31, s31, 0x80000
  s_and_b32 s31, s31, 0x180000
  s_add_u32 s20, s30, s31
  s_waitcnt vmcnt(4)
  buffer_load_dwordx4 v[176:179], v2, s[8:11], s20 offen offset:0 nt
  s_waitcnt vmcnt(4)
  buffer_load_dwordx4 v[180:183], v2, s[8:11], s20 offen offset:1024 nt
  s_waitcnt vmcnt(4)
  buffer_load_dwordx4 v[184:187], v2, s[8:11], s20 offen offset:2048 nt
  s_waitcnt vmcnt(4)
  buffer_load_dwordx4 v[188:191], v2, s[8:11], s20 offen offset:3072 nt
  s_add_u32 s30, s30, s21
  s_add_u32 s31, s31, 0x80000
  s_and_b32 s31, s31, 0x180000
  s_add_u32 s20, s30, s31
  s_waitcnt vmcnt(4)
  buffer_load_dwordx4 v[192:195], v2, s[8:11], s20 offen offset:0 nt
  s_waitcnt vmcnt(4)
  buffer_load_dwordx4 v[196:199], v2, s[8:11], s20 offen offset:1024 nt
  s_waitcnt vmcnt(4)
  buffer_load_dwordx4 v[200:203], v2, s[8:11], s20 offen offset:2048 nt
  s_waitcnt vmcnt(4)
  buffer_load_dwordx4 v[204:207], v2, s[8:11], s20 offen offset:3072 nt
  s_add_u32 s30, s30, s21
  s_add_u32 s31, s31, 0x80000
  s_and_b32 s31, s31, 0x180000
  s_add_u32 s20, s30, s31
  s_waitcnt vmcnt(4)
  buffer_load_dwordx4 v[208:211], v2, s[8:11], s20 offen offset:0 nt
  s_waitcnt vmcnt(4)
  buffer_load_dwordx4 v[212:215], v2, s[8:11], s20 offen offset:1024 nt
  s_waitcnt vmcnt(4)
  buffer_load_dwordx4 v[216:219], v2, s[8:11], s20 offen offset:2048 nt
  s_waitcnt vmcnt(4)
  buffer_load_dwordx4 v[220:223], v2, s[8:11], s20 offen offset:3072 nt
  s_add_u32 s30, s30, s21
  s_add_u32 s31, s31, 0x80000
  s_and_b32 s31, s31, 0x180000
  s_add_u32 s20, s30, s31
  s_waitcnt vmcnt(4)
  buffer_load_dwordx4 v[224:227], v2, s[8:11], s20 offen offset:0 nt
  s_waitcnt vmcnt(4)
  buffer_load_dwordx4 v[228:231], v2, s[8:11], s20 offen offset:1024 nt
  s_waitcnt vmcnt(4)
  buffer_load_dwordx4 v[232:235], v2, s[8:11], s20 offen offset:2048 nt
  s_waitcnt vmcnt(4)
  buffer_load_dwordx4 v[236:239], v2, s[8:11], s20 offen offset:3072 nt
  s_add_u32 s30, s30, s21
  s_add_u32 s31, s31, 0x80000
  s_and_b32 s31, s31, 0x180000
  s_add_u32 s20, s30, s31
  s_barrier
  ds_read_b128 v[56:59], v4 offset:0
  ds_read_b128 v[60:63], v4 offset:16
  s_waitcnt lgkmcnt(0)
  v_cvt_pk_bf16_f32 v48, v56, v57
  v_cvt_pk_bf16_f32 v49, v58, v59
  v_cvt_pk_bf16_f32 v50, v60, v61
  v_cvt_pk_bf16_f32 v51, v62, v63
  s_mov_b32 s26, 0xf000f
  s_mov_b32 s27, 0xf000f
  v_cndmask_b32_e64 v12, 0, v48, s[26:27]
  v_cndmask_b32_e64 v13, 0, v49, s[26:27]
  v_cndmask_b32_e64 v14, 0, v50, s[26:27]
  v_cndmask_b32_e64 v15, 0, v51, s[26:27]
  s_mov_b32 s26, 0xf000f0
  s_mov_b32 s27, 0xf000f0
  v_cndmask_b32_e64 v16, 0, v48, s[26:27]
  v_cndmask_b32_e64 v17, 0, v49, s[26:27]
  v_cndmask_b32_e64 v18, 0, v50, s[26:27]
  v_cndmask_b32_e64 v19, 0, v51, s[26:27]
  s_mov_b32 s26, 0xf000f00
  s_mov_b32 s27, 0xf000f00
  v_cndmask_b32_e64 v20, 0, v48, s[26:27]
  v_cndmask_b32_e64 v21, 0, v49, s[26:27]
  v_cndmask_b32_e64 v22, 0, v50, s[26:27]
  v_cndmask_b32_e64 v23, 0, v51, s[26:27]
  s_mov_b32 s26, 0xf000f000
  s_mov_b32 s27, 0xf000f000
  v_cndmask_b32_e64 v24, 0, v48, s[26:27]
  v_cndmask_b32_e64 v25, 0, v49, s[26:27]
  v_cndmask_b32_e64 v26, 0, v50, s[26:27]
  v_cndmask_b32_e64 v27, 0, v51, s[26:27]
  s_add_u32 s95, s95, 1
  s_and_b32 s93, s95, 0x3ff
  s_mov_b32 s92, 0xfffffc00
  v_mov_b32 v47, s93
  v_mfma_f32_16x16x32_bf16 v[28:31], v[12:15], v[64:67], 0
  v_mfma_f32_16x16x32_bf16 v[28:31], v[16:19], v[68:71], v[28:31]
  s_waitcnt vmcnt(4)
  buffer_load_dwordx4 v[64:67], v2, s[8:11], s20 offen offset:0 nt
  v_mfma_f32_16x16x32_bf16 v[28:31], v[20:23], v[72:75], v[28:31]
  v_mfma_f32_16x16x32_bf16 v[28:31], v[24:27], v[76:79], v[28:31]
  s_waitcnt vmcnt(4)
  buffer_load_dwordx4 v[68:71], v2, s[8:11], s20 offen offset:1024 nt
  v_mfma_f32_16x16x32_bf16 v[32:35], v[12:15], v[80:83], 0
  s_nop 4
  v_mov_b32_dpp v43, v28 quad_perm:[0,0,0,0] row_mask:0xf bank_mask:0xf
  v_add_f32_dpp v43, v29, v43 quad_perm:[1,1,1,1] row_mask:0xf bank_mask:0xf
  v_add_f32_dpp v43, v30, v43 quad_perm:[2,2,2,2] row_mask:0xf bank_mask:0xf
  v_add_f32_dpp v43, v31, v43 quad_perm:[3,3,3,3] row_mask:0xf bank_mask:0xf
  v_cvt_pk_bf16_f32 v43, v43, v43
  v_lshlrev_b32 v43, 16, v43
  v_mul_f32 v43, s25, v43
  v_cvt_pk_bf16_f32 v43, v43, v43
  v_lshlrev_b32 v43, 16, v43
  ds_write_b32 v36, v43 offset:0
  v_mov_b32 v40, v43
  v_mfma_f32_16x16x32_bf16 v[32:35], v[16:19], v[84:87], v[32:35]
  s_waitcnt vmcnt(4)
  buffer_load_dwordx4 v[72:75], v2, s[8:11], s20 offen offset:2048 nt
  v_mfma_f32_16x16x32_bf16 v[32:35], v[20:23], v[88:91], v[32:35]
  v_mfma_f32_16x16x32_bf16 v[32:35], v[24:27], v[92:95], v[32:35]
  s_waitcnt vmcnt(4)
  buffer_load_dwordx4 v[76:79], v2, s[8:11], s20 offen offset:3072 nt
  s_add_u32 s30, s30, s21
  s_add_u32 s31, s31, 0x80000
  s_and_b32 s31, s31, 0x180000
  s_add_u32 s20, s30, s31
  v_mfma_f32_16x16x32_bf16 v[28:31], v[12:15], v[96:99], 0
  s_nop 0
  v_mov_b32_dpp v43, v32 quad_perm:[0,0,0,0] row_mask:0xf bank_mask:0xf
  v_add_f32_dpp v43, v33, v43 quad_perm:[1,1,1,1] row_mask:0xf bank_mask:0xf
  v_add_f32_dpp v43, v34, v43 quad_perm:[2,2,2,2] row_mask:0xf bank_mask:0xf
  v_add_f32_dpp v43, v35, v43 quad_perm:[3,3,3,3] row_mask:0xf bank_mask:0xf
  v_cvt_pk_bf16_f32 v43, v43, v43
  v_lshlrev_b32 v43, 16, v43
  v_mul_f32 v43, s25, v43
  v_cvt_pk_bf16_f32 v43, v43, v43
  v_lshlrev_b32 v43, 16, v43
  ds_write_b32 v36, v43 offset:256
  v_max_f32 v40, v40, v43
  v_mfma_f32_16x16x32_bf16 v[28:31], v[16:19], v[100:103], v[28:31]
  s_waitcnt vmcnt(4)
  buffer_load_dwordx4 v[96:99], v2, s[8:11], s20 offen offset:0 nt
  v_mfma_f32_16x16x32_bf16 v[28:31], v[20:23], v[104:107], v[28:31]
  v_mfma_f32_16x16x32_bf16 v[28:31], v[24:27], v[108:111], v[28:31]
  s_waitcnt vmcnt(4)
  buffer_load_dwordx4 v[100:103], v2, s[8:11], s20 offen offset:1024 nt
  v_mfma_f32_16x16x32_bf16 v[32:35], v[12:15], v[112:115], 0
  s_nop 4
  v_mov_b32_dpp v43, v28 quad_perm:[0,0,0,0] row_mask:0xf bank_mask:0xf
  v_add_f32_dpp v43, v29, v43 quad_perm:[1,1,1,1] row_mask:0xf bank_mask:0xf
  v_add_f32_dpp v43, v30, v43 quad_perm:[2,2,2,2] row_mask:0xf bank_mask:0xf
  v_add_f32_dpp v43, v31, v43 quad_perm:[3,3,3,3] row_mask:0xf bank_mask:0xf
  v_cvt_pk_bf16_f32 v43, v43, v43
  v_lshlrev_b32 v43, 16, v43
  v_mul_f32 v43, s25, v43
  v_cvt_pk_bf16_f32 v43, v43, v43
  v_lshlrev_b32 v43, 16, v43
  ds_write_b32 v36, v43 offset:512
  v_max_f32 v40, v40, v43
  v_mfma_f32_16x16x32_bf16 v[32:35], v[16:19], v[116:119], v[32:35]
  s_waitcnt vmcnt(4)
  buffer_load_dwordx4 v[104:107], v2, s[8:11], s20 offen offset:2048 nt
  v_mfma_f32_16x16x32_bf16 v[32:35], v[20:23], v[120:123], v[32:35]
  v_mfma_f32_16x16x32_bf16 v[32:35], v[24:27], v[124:127], v[32:35]
  s_waitcnt vmcnt(4)
  buffer_load_dwordx4 v[108:111], v2, s[8:11], s20 offen offset:3072 nt
  s_add_u32 s30, s30, s21
  s_add_u32 s31, s31, 0x80000
  s_and_b32 s31, s31, 0x180000
  s_add_u32 s20, s30, s31
  v_mfma_f32_16x16x32_bf16 v[28:31], v[12:15], v[128:131], 0
  s_nop 0
  v_mov_b32_dpp v43, v32 quad_perm:[0,0,0,0] row_mask:0xf bank_mask:0xf
  v_add_f32_dpp v43, v33, v43 quad_perm:[1,1,1,1] row_mask:0xf bank_mask:0xf
  v_add_f32_dpp v43, v34, v43 quad_perm:[2,2,2,2] row_mask:0xf bank_mask:0xf
  v_add_f32_dpp v43, v35, v43 quad_perm:[3,3,3,3] row_mask:0xf bank_mask:0xf
  v_cvt_pk_bf16_f32 v43, v43, v43
  v_lshlrev_b32 v43, 16, v43
  v_mul_f32 v43, s25, v43
  v_cvt_pk_bf16_f32 v43, v43, v43
  v_lshlrev_b32 v43, 16, v43
  ds_write_b32 v36, v43 offset:768
  v_max_f32 v40, v40, v43
  v_mfma_f32_16x16x32_bf16 v[28:31], v[16:19], v[132:135], v[28:31]
  s_waitcnt vmcnt(4)
  buffer_load_dwordx4 v[112:115], v2, s[8:11], s20 offen offset:0 nt
  v_mfma_f32_16x16x32_bf16 v[28:31], v[20:23], v[136:139], v[28:31]
  v_mfma_f32_16x16x32_bf16 v[28:31], v[24:27], v[140:143], v[28:31]
  s_waitcnt vmcnt(4)
  buffer_load_dwordx4 v[116:119], v2, s[8:11], s20 offen offset:1024 nt
  v_mfma_f32_16x16x32_bf16 v[32:35], v[12:15], v[144:147], 0
  s_nop 4
  v_mov_b32_dpp v43, v28 quad_perm:[0,0,0,0] row_mask:0xf bank_mask:0xf
  v_add_f32_dpp v43, v29, v43 quad_perm:[1,1,1,1] row_mask:0xf bank_mask:0xf
  v_add_f32_dpp v43, v30, v43 quad_perm:[2,2,2,2] row_mask:0xf bank_mask:0xf
  v_add_f32_dpp v43, v31, v43 quad_perm:[3,3,3,3] row_mask:0xf bank_mask:0xf
  v_cvt_pk_bf16_f32 v43, v43, v43
  v_lshlrev_b32 v43, 16, v43
  v_mul_f32 v43, s25, v43
  v_cvt_pk_bf16_f32 v43, v43, v43
  v_lshlrev_b32 v43, 16, v43
  ds_write_b32 v36, v43 offset:1024
  v_max_f32 v40, v40, v43
  v_mfma_f32_16x16x32_bf16 v[32:35], v[16:19], v[148:151], v[32:35]
  s_waitcnt vmcnt(4)
  buffer_load_dwordx4 v[120:123], v2, s[8:11], s20 offen offset:2048 nt
  v_mfma_f32_16x16x32_bf16 v[32:35], v[20:23], v[152:155], v[32:35]
  v_mfma_f32_16x16x32_bf16 v[32:35], v[24:27], v[156:159], v[32:35]
  s_waitcnt vmcnt(4)
  buffer_load_dwordx4 v[124:127], v2, s[8:11], s20 offen offset:3072 nt
  s_add_u32 s30, s30, s21
  s_add_u32 s31, s31, 0x80000
  s_and_b32 s31, s31, 0x180000
  s_add_u32 s20, s30, s31
  v_mfma_f32_16x16x32_bf16 v[28:31], v[12:15], v[160:163], 0
  s_nop 0
  v_mov_b32_dpp v43, v32 quad_perm:[0,0,0,0] row_mask:0xf bank_mask:0xf
  v_add_f32_dpp v43, v33, v43 quad_perm:[1,1,1,1] row_mask:0xf bank_mask:0xf
  v_add_f32_dpp v43, v34, v43 quad_perm:[2,2,2,2] row_mask:0xf bank_mask:0xf
  v_add_f32_dpp v43, v35, v43 quad_perm:[3,3,3,3] row_mask:0xf bank_mask:0xf
  v_cvt_pk_bf16_f32 v43, v43, v43
  v_lshlrev_b32 v43, 16, v43
  v_mul_f32 v43, s25, v43
  v_cvt_pk_bf16_f32 v43, v43, v43
  v_lshlrev_b32 v43, 16, v43
  ds_write_b32 v36, v43 offset:1280
  v_max_f32 v40, v40, v43
  v_mfma_f32_16x16x32_bf16 v[28:31], v[16:19], v[164:167], v[28:31]
  s_waitcnt vmcnt(4)
  buffer_load_dwordx4 v[128:131], v2, s[8:11], s20 offen offset:0 nt
  v_mfma_f32_16x16x32_bf16 v[28:31], v[20:23], v[168:171], v[28:31]
  v_mfma_f32_16x16x32_bf16 v[28:31], v[24:27], v[172:175], v[28:31]
  s_waitcnt vmcnt(4)
  buffer_load_dwordx4 v[132:135], v2, s[8:11], s20 offen offset:1024 nt
  v_mfma_f32_16x16x32_bf16 v[32:35], v[12:15], v[176:179], 0
  s_nop 4
  v_mov_b32_dpp v43, v28 quad_perm:[0,0,0,0] row_mask:0xf bank_mask:0xf
  v_add_f32_dpp v43, v29, v43 quad_perm:[1,1,1,1] row_mask:0xf bank_mask:0xf
  v_add_f32_dpp v43, v30, v43 quad_perm:[2,2,2,2] row_mask:0xf bank_mask:0xf
  v_add_f32_dpp v43, v31, v43 quad_perm:[3,3,3,3] row_mask:0xf bank_mask:0xf
  v_cvt_pk_bf16_f32 v43, v43, v43
  v_lshlrev_b32 v43, 16, v43
  v_mul_f32 v43, s25, v43
  v_cvt_pk_bf16_f32 v43, v43, v43
  v_lshlrev_b32 v43, 16, v43
  ds_write_b32 v36, v43 offset:1536
  v_max_f32 v40, v40, v43
  v_mfma_f32_16x16x32_bf16 v[32:35], v[16:19], v[180:183], v[32:35]
  s_waitcnt vmcnt(4)
  buffer_load_dwordx4 v[136:139], v2, s[8:11], s20 offen offset:2048 nt
  v_mfma_f32_16x16x32_bf16 v[32:35], v[20:23], v[184:187], v[32:35]
  v_mfma_f32_16x16x32_bf16 v[32:35], v[24:27], v[188:191], v[32:35]
  s_waitcnt vmcnt(4)
  buffer_load_dwordx4 v[140:143], v2, s[8:11], s20 offen offset:3072 nt
  s_add_u32 s30, s30, s21
  s_add_u32 s31, s31, 0x80000
  s_and_b32 s31, s31, 0x180000
  s_add_u32 s20, s30, s31
  v_mfma_f32_16x16x32_bf16 v[28:31], v[12:15], v[192:195], 0
  s_nop 0
  v_mov_b32_dpp v43, v32 quad_perm:[0,0,0,0] row_mask:0xf bank_mask:0xf
  v_add_f32_dpp v43, v33, v43 quad_perm:[1,1,1,1] row_mask:0xf bank_mask:0xf
  v_add_f32_dpp v43, v34, v43 quad_perm:[2,2,2,2] row_mask:0xf bank_mask:0xf
  v_add_f32_dpp v43, v35, v43 quad_perm:[3,3,3,3] row_mask:0xf bank_mask:0xf
  v_cvt_pk_bf16_f32 v43, v43, v43
  v_lshlrev_b32 v43, 16, v43
  v_mul_f32 v43, s25, v43
  v_cvt_pk_bf16_f32 v43, v43, v43
  v_lshlrev_b32 v43, 16, v43
  ds_write_b32 v36, v43 offset:1792
  v_max_f32 v40, v40, v43
  v_mfma_f32_16x16x32_bf16 v[28:31], v[16:19], v[196:199], v[28:31]
  s_waitcnt vmcnt(4)
  buffer_load_dwordx4 v[144:147], v2, s[8:11], s20 offen offset:0 nt
  v_mfma_f32_16x16x32_bf16 v[28:31], v[20:23], v[200:203], v[28:31]
  v_mfma_f32_16x16x32_bf16 v[28:31], v[24:27], v[204:207], v[28:31]
  s_waitcnt vmcnt(4)
  buffer_load_dwordx4 v[148:151], v2, s[8:11], s20 offen offset:1024 nt
  v_mfma_f32_16x16x32_bf16 v[32:35], v[12:15], v[208:211], 0
  s_nop 4
  v_mov_b32_dpp v43, v28 quad_perm:[0,0,0,0] row_mask:0xf bank_mask:0xf
  v_add_f32_dpp v43, v29, v43 quad_perm:[1,1,1,1] row_mask:0xf bank_mask:0xf
  v_add_f32_dpp v43, v30, v43 quad_perm:[2,2,2,2] row_mask:0xf bank_mask:0xf
  v_add_f32_dpp v43, v31, v43 quad_perm:[3,3,3,3] row_mask:0xf bank_mask:0xf
  v_cvt_pk_bf16_f32 v43, v43, v43
  v_lshlrev_b32 v43, 16, v43
  v_mul_f32 v43, s25, v43
  v_cvt_pk_bf16_f32 v43, v43, v43
  v_lshlrev_b32 v43, 16, v43
  ds_write_b32 v36, v43 offset:2048
  v_max_f32 v40, v40, v43
  v_mfma_f32_16x16x32_bf16 v[32:35], v[16:19], v[212:215], v[32:35]
  s_waitcnt vmcnt(4)
  buffer_load_dwordx4 v[152:155], v2, s[8:11], s20 offen offset:2048 nt
  v_mfma_f32_16x16x32_bf16 v[32:35], v[20:23], v[216:219], v[32:35]
  v_mfma_f32_16x16x32_bf16 v[32:35], v[24:27], v[220:223], v[32:35]
  s_waitcnt vmcnt(4)
  buffer_load_dwordx4 v[156:159], v2, s[8:11], s20 offen offset:3072 nt
  s_add_u32 s30, s30, s21
  s_add_u32 s31, s31, 0x80000
  s_and_b32 s31, s31, 0x180000
  s_add_u32 s20, s30, s31
  v_mfma_f32_16x16x32_bf16 v[28:31], v[12:15], v[224:227], 0
  s_nop 0
  v_mov_b32_dpp v43, v32 quad_perm:[0,0,0,0] row_mask:0xf bank_mask:0xf
  v_add_f32_dpp v43, v33, v43 quad_perm:[1,1,1,1] row_mask:0xf bank_mask:0xf
  v_add_f32_dpp v43, v34, v43 quad_perm:[2,2,2,2] row_mask:0xf bank_mask:0xf
  v_add_f32_dpp v43, v35, v43 quad_perm:[3,3,3,3] row_mask:0xf bank_mask:0xf
  v_cvt_pk_bf16_f32 v43, v43, v43
  v_lshlrev_b32 v43, 16, v43
  v_mul_f32 v43, s25, v43
  v_cvt_pk_bf16_f32 v43, v43, v43
  v_lshlrev_b32 v43, 16, v43
  ds_write_b32 v36, v43 offset:2304
  v_max_f32 v40, v40, v43
  v_mfma_f32_16x16x32_bf16 v[28:31], v[16:19], v[228:231], v[28:31]
  s_waitcnt vmcnt(4)
  buffer_load_dwordx4 v[160:163], v2, s[8:11], s20 offen offset:0 nt
  v_mfma_f32_16x16x32_bf16 v[28:31], v[20:23], v[232:235], v[28:31]
  v_mfma_f32_16x16x32_bf16 v[28:31], v[24:27], v[236:239], v[28:31]
  s_waitcnt vmcnt(4)
  buffer_load_dwordx4 v[164:167], v2, s[8:11], s20 offen offset:1024 nt
  v_mfma_f32_16x16x32_bf16 v[32:35], v[12:15], v[64:67], 0
  s_nop 4
  v_mov_b32_dpp v43, v28 quad_perm:[0,0,0,0] row_mask:0xf bank_mask:0xf
  v_add_f32_dpp v43, v29, v43 quad_perm:[1,1,1,1] row_mask:0xf bank_mask:0xf
  v_add_f32_dpp v43, v30, v43 quad_perm:[2,2,2,2] row_mask:0xf bank_mask:0xf
  v_add_f32_dpp v43, v31, v43 quad_perm:[3,3,3,3] row_mask:0xf bank_mask:0xf
  v_cvt_pk_bf16_f32 v43, v43, v43
  v_lshlrev_b32 v43, 16, v43
  v_mul_f32 v43, s25, v43
  v_cvt_pk_bf16_f32 v43, v43, v43
  v_lshlrev_b32 v43, 16, v43
  ds_write_b32 v36, v43 offset:2560
  v_max_f32 v40, v40, v43
  v_mfma_f32_16x16x32_bf16 v[32:35], v[16:19], v[68:71], v[32:35]
  s_waitcnt vmcnt(4)
  buffer_load_dwordx4 v[168:171], v2, s[8:11], s20 offen offset:2048 nt
  v_mfma_f32_16x16x32_bf16 v[32:35], v[20:23], v[72:75], v[32:35]
  v_mfma_f32_16x16x32_bf16 v[32:35], v[24:27], v[76:79], v[32:35]
  s_waitcnt vmcnt(4)
  buffer_load_dwordx4 v[172:175], v2, s[8:11], s20 offen offset:3072 nt
  s_add_u32 s30, s30, s21
  s_add_u32 s31, s31, 0x80000
  s_and_b32 s31, s31, 0x180000
  s_add_u32 s20, s30, s31
  v_mfma_f32_16x16x32_bf16 v[28:31], v[12:15], v[96:99], 0
  s_nop 0
  v_mov_b32_dpp v43, v32 quad_perm:[0,0,0,0] row_mask:0xf bank_mask:0xf
  v_add_f32_dpp v43, v33, v43 quad_perm:[1,1,1,1] row_mask:0xf bank_mask:0xf
  v_add_f32_dpp v43, v34, v43 quad_perm:[2,2,2,2] row_mask:0xf bank_mask:0xf
  v_add_f32_dpp v43, v35, v43 quad_perm:[3,3,3,3] row_mask:0xf bank_mask:0xf
  v_cvt_pk_bf16_f32 v43, v43, v43
  v_lshlrev_b32 v43, 16, v43
  v_mul_f32 v43, s25, v43
  v_cvt_pk_bf16_f32 v43, v43, v43
  v_lshlrev_b32 v43, 16, v43
  ds_write_b32 v36, v43 offset:2816
  v_max_f32 v40, v40, v43
  v_mfma_f32_16x16x32_bf16 v[28:31], v[16:19], v[100:103], v[28:31]
  s_waitcnt vmcnt(4)
  buffer_load_dwordx4 v[96:99], v2, s[8:11], s20 offen offset:0 nt
  v_mfma_f32_16x16x32_bf16 v[28:31], v[20:23], v[104:107], v[28:31]
  v_mfma_f32_16x16x32_bf16 v[28:31], v[24:27], v[108:111], v[28:31]
  s_waitcnt vmcnt(4)
  buffer_load_dwordx4 v[100:103], v2, s[8:11], s20 offen offset:1024 nt
  v_mfma_f32_16x16x32_bf16 v[32:35], v[12:15], v[112:115], 0
  s_nop 4
  v_mov_b32_dpp v43, v28 quad_perm:[0,0,0,0] row_mask:0xf bank_mask:0xf
  v_add_f32_dpp v43, v29, v43 quad_perm:[1,1,1,1] row_mask:0xf bank_mask:0xf
  v_add_f32_dpp v43, v30, v43 quad_perm:[2,2,2,2] row_mask:0xf bank_mask:0xf
  v_add_f32_dpp v43, v31, v43 quad_perm:[3,3,3,3] row_mask:0xf bank_mask:0xf
  v_cvt_pk_bf16_f32 v43, v43, v43
  v_lshlrev_b32 v43, 16, v43
  v_mul_f32 v43, s25, v43
  v_cvt_pk_bf16_f32 v43, v43, v43
  v_lshlrev_b32 v43, 16, v43
  ds_write_b32 v36, v43 offset:3072
  v_max_f32 v40, v40, v43
  v_mfma_f32_16x16x32_bf16 v[32:35], v[16:19], v[116:119], v[32:35]
  s_waitcnt vmcnt(4)
  buffer_load_dwordx4 v[104:107], v2, s[8:11], s20 offen offset:2048 nt
  v_mfma_f32_16x16x32_bf16 v[32:35], v[20:23], v[120:123], v[32:35]
  v_mfma_f32_16x16x32_bf16 v[32:35], v[24:27], v[124:127], v[32:35]
  s_waitcnt vmcnt(4)
  buffer_load_dwordx4 v[92:95], v2, s[8:11], s20 offen offset:3072 nt
  s_add_u32 s30, s30, s21
  s_add_u32 s31, s31, 0x80000
  s_and_b32 s31, s31, 0x180000
  s_add_u32 s20, s30, s31
  v_mfma_f32_16x16x32_bf16 v[28:31], v[12:15], v[128:131], 0
  s_nop 0
  v_mov_b32_dpp v43, v32 quad_perm:[0,0,0,0] row_mask:0xf bank_mask:0xf
  v_add_f32_dpp v43, v33, v43 quad_perm:[1,1,1,1] row_mask:0xf bank_mask:0xf
  v_add_f32_dpp v43, v34, v43 quad_perm:[2,2,2,2] row_mask:0xf bank_mask:0xf
  v_add_f32_dpp v43, v35, v43 quad_perm:[3,3,3,3] row_mask:0xf bank_mask:0xf
  v_cvt_pk_bf16_f32 v43, v43, v43
  v_lshlrev_b32 v43, 16, v43
  v_mul_f32 v43, s25, v43
  v_cvt_pk_bf16_f32 v43, v43, v43
  v_lshlrev_b32 v43, 16, v43
  ds_write_b32 v36, v43 offset:3328
  v_max_f32 v40, v40, v43
  v_mfma_f32_16x16x32_bf16 v[28:31], v[16:19], v[132:135], v[28:31]
  s_waitcnt vmcnt(4)
  buffer_load_dwordx4 v[64:67], v2, s[8:11], s20 offen offset:0 nt
  v_mfma_f32_16x16x32_bf16 v[28:31], v[20:23], v[136:139], v[28:31]
  v_mfma_f32_16x16x32_bf16 v[28:31], v[24:27], v[140:143], v[28:31]
  s_waitcnt vmcnt(4)
  buffer_load_dwordx4 v[68:71], v2, s[8:11], s20 offen offset:1024 nt
  v_mfma_f32_16x16x32_bf16 v[32:35], v[12:15], v[144:147], 0
  s_nop 4
  v_mov_b32_dpp v43, v28 quad_perm:[0,0,0,0] row_mask:0xf bank_mask:0xf
  v_add_f32_dpp v43, v29, v43 quad_perm:[1,1,1,1] row_mask:0xf bank_mask:0xf
  v_add_f32_dpp v43, v30, v43 quad_perm:[2,2,2,2] row_mask:0xf bank_mask:0xf
  v_add_f32_dpp v43, v31, v43 quad_perm:[3,3,3,3] row_mask:0xf bank_mask:0xf
  v_cvt_pk_bf16_f32 v43, v43, v43
  v_lshlrev_b32 v43, 16, v43
  v_mul_f32 v43, s25, v43
  v_cvt_pk_bf16_f32 v43, v43, v43
  v_lshlrev_b32 v43, 16, v43
  ds_write_b32 v36, v43 offset:3584
  v_max_f32 v40, v40, v43
  v_mfma_f32_16x16x32_bf16 v[32:35], v[16:19], v[148:151], v[32:35]
  s_waitcnt vmcnt(4)
  buffer_load_dwordx4 v[72:75], v2, s[8:11], s20 offen offset:2048 nt
  v_mfma_f32_16x16x32_bf16 v[32:35], v[20:23], v[152:155], v[32:35]
  v_mfma_f32_16x16x32_bf16 v[32:35], v[24:27], v[156:159], v[32:35]
  s_waitcnt vmcnt(4)
  buffer_load_dwordx4 v[76:79], v2, s[8:11], s20 offen offset:3072 nt
  s_add_u32 s30, s30, s21
  s_add_u32 s31, s31, 0x80000
  s_and_b32 s31, s31, 0x180000
  s_add_u32 s20, s30, s31
  v_mfma_f32_16x16x32_bf16 v[28:31], v[12:15], v[160:163], 0
  s_nop 0
  v_mov_b32_dpp v43, v32 quad_perm:[0,0,0,0] row_mask:0xf bank_mask:0xf
  v_add_f32_dpp v43, v33, v43 quad_perm:[1,1,1,1] row_mask:0xf bank_mask:0xf
  v_add_f32_dpp v43, v34, v43 quad_perm:[2,2,2,2] row_mask:0xf bank_mask:0xf
  v_add_f32_dpp v43, v35, v43 quad_perm:[3,3,3,3] row_mask:0xf bank_mask:0xf
  v_cvt_pk_bf16_f32 v43, v43, v43
  v_lshlrev_b32 v43, 16, v43
  v_mul_f32 v43, s25, v43
  v_cvt_pk_bf16_f32 v43, v43, v43
  v_lshlrev_b32 v43, 16, v43
  ds_write_b32 v36, v43 offset:3840
  v_max_f32 v40, v40, v43
  v_mfma_f32_16x16x32_bf16 v[28:31], v[16:19], v[164:167], v[28:31]
  s_waitcnt vmcnt(4)
  buffer_load_dwordx4 v[80:83], v2, s[8:11], s20 offen offset:0 nt
  v_mfma_f32_16x16x32_bf16 v[28:31], v[20:23], v[168:171], v[28:31]
  v_mfma_f32_16x16x32_bf16 v[28:31], v[24:27], v[172:175], v[28:31]
  s_waitcnt vmcnt(4)
  buffer_load_dwordx4 v[84:87], v2, s[8:11], s20 offen offset:1024 nt
  v_mfma_f32_16x16x32_bf16 v[32:35], v[12:15], v[96:99], 0
  s_nop 4
  v_mov_b32_dpp v43, v28 quad_perm:[0,0,0,0] row_mask:0xf bank_mask:0xf
  v_add_f32_dpp v43, v29, v43 quad_perm:[1,1,1,1] row_mask:0xf bank_mask:0xf
  v_add_f32_dpp v43, v30, v43 quad_perm:[2,2,2,2] row_mask:0xf bank_mask:0xf
  v_add_f32_dpp v43, v31, v43 quad_perm:[3,3,3,3] row_mask:0xf bank_mask:0xf
  v_cvt_pk_bf16_f32 v43, v43, v43
  v_lshlrev_b32 v43, 16, v43
  v_mul_f32 v43, s25, v43
  v_cvt_pk_bf16_f32 v43, v43, v43
  v_lshlrev_b32 v43, 16, v43
  ds_write_b32 v36, v43 offset:4096
  v_max_f32 v40, v40, v43
  v_mfma_f32_16x16x32_bf16 v[32:35], v[16:19], v[100:103], v[32:35]
  s_waitcnt vmcnt(4)
  buffer_load_dwordx4 v[88:91], v2, s[8:11], s20 offen offset:2048 nt
  v_mfma_f32_16x16x32_bf16 v[32:35], v[20:23], v[104:107], v[32:35]
  v_mfma_f32_16x16x32_bf16 v[32:35], v[24:27], v[92:95], v[32:35]
  s_waitcnt vmcnt(4)
  buffer_load_dwordx4 v[92:95], v2, s[8:11], s20 offen offset:3072 nt
  s_add_u32 s30, s30, s21
  s_add_u32 s31, s31, 0x80000
  s_and_b32 s31, s31, 0x180000
  s_add_u32 s20, s30, s31
  v_mfma_f32_16x16x32_bf16 v[28:31], v[12:15], v[64:67], 0
  s_nop 0
  v_mov_b32_dpp v43, v32 quad_perm:[0,0,0,0] row_mask:0xf bank_mask:0xf
  v_add_f32_dpp v43, v33, v43 quad_perm:[1,1,1,1] row_mask:0xf bank_mask:0xf
  v_add_f32_dpp v43, v34, v43 quad_perm:[2,2,2,2] row_mask:0xf bank_mask:0xf
  v_add_f32_dpp v43, v35, v43 quad_perm:[3,3,3,3] row_mask:0xf bank_mask:0xf
  v_cvt_pk_bf16_f32 v43, v43, v43
  v_lshlrev_b32 v43, 16, v43
  v_mul_f32 v43, s25, v43
  v_cvt_pk_bf16_f32 v43, v43, v43
  v_lshlrev_b32 v43, 16, v43
  ds_write_b32 v36, v43 offset:4352
  v_max_f32 v40, v40, v43
  v_mfma_f32_16x16x32_bf16 v[28:31], v[16:19], v[68:71], v[28:31]
  s_waitcnt vmcnt(4)
  buffer_load_dwordx4 v[64:67], v2, s[8:11], s20 offen offset:0 nt
  v_mfma_f32_16x16x32_bf16 v[28:31], v[20:23], v[72:75], v[28:31]
  v_mfma_f32_16x16x32_bf16 v[28:31], v[24:27], v[76:79], v[28:31]
  s_waitcnt vmcnt(4)
  buffer_load_dwordx4 v[68:71], v2, s[8:11], s20 offen offset:1024 nt
  v_mfma_f32_16x16x32_bf16 v[32:35], v[12:15], v[80:83], 0
  s_nop 4
  v_mov_b32_dpp v43, v28 quad_perm:[0,0,0,0] row_mask:0xf bank_mask:0xf
  v_add_f32_dpp v43, v29, v43 quad_perm:[1,1,1,1] row_mask:0xf bank_mask:0xf
  v_add_f32_dpp v43, v30, v43 quad_perm:[2,2,2,2] row_mask:0xf bank_mask:0xf
  v_add_f32_dpp v43, v31, v43 quad_perm:[3,3,3,3] row_mask:0xf bank_mask:0xf
  v_cvt_pk_bf16_f32 v43, v43, v43
  v_lshlrev_b32 v43, 16, v43
  v_mul_f32 v43, s25, v43
  v_cvt_pk_bf16_f32 v43, v43, v43
  v_lshlrev_b32 v43, 16, v43
  ds_write_b32 v36, v43 offset:4608
  v_max_f32 v40, v40, v43
  s_waitcnt vmcnt(4)
  buffer_load_dwordx4 v[72:75], v2, s[8:11], s20 offen offset:2048 nt
  v_mfma_f32_16x16x32_bf16 v[32:35], v[16:19], v[84:87], v[32:35]
  s_waitcnt vmcnt(4)
  buffer_load_dwordx4 v[76:79], v2, s[8:11], s20 offen offset:3072 nt
  s_add_u32 s30, s30, s21
  s_add_u32 s31, s31, 0x80000
  s_and_b32 s31, s31, 0x180000
  s_add_u32 s20, s30, s31
  v_mfma_f32_16x16x32_bf16 v[32:35], v[20:23], v[88:91], v[32:35]
  s_waitcnt vmcnt(4)
  buffer_load_dwordx4 v[80:83], v2, s[8:11], s20 offen offset:0 nt
  v_mfma_f32_16x16x32_bf16 v[32:35], v[24:27], v[92:95], v[32:35]
  s_mov_b32 s28, 5
  s_nop 6
L_loopK:
  s_waitcnt vmcnt(4)
  buffer_load_dwordx4 v[84:87], v2, s[8:11], s20 offen offset:1024 nt
  v_mfma_f32_16x16x32_bf16 v[28:31], v[12:15], v[64:67], 0
  v_mov_b32_dpp v43, v32 quad_perm:[0,0,0,0] row_mask:0xf bank_mask:0xf
  v_add_f32_dpp v43, v33, v43 quad_perm:[1,1,1,1] row_mask:0xf bank_mask:0xf
  v_add_f32_dpp v43, v34, v43 quad_perm:[2,2,2,2] row_mask:0xf bank_mask:0xf
  v_add_f32_dpp v43, v35, v43 quad_perm:[3,3,3,3] row_mask:0xf bank_mask:0xf
  v_cvt_pk_bf16_f32 v43, v43, v43
  v_lshlrev_b32 v43, 16, v43
  v_mul_f32 v43, s25, v43
  v_cvt_pk_bf16_f32 v43, v43, v43
  v_lshlrev_b32 v43, 16, v43
  ds_write_b32 v36, v43 offset:4864
  v_max_f32 v40, v40, v43
  s_waitcnt vmcnt(4)
  buffer_load_dwordx4 v[88:91], v2, s[8:11], s20 offen offset:2048 nt
  v_mfma_f32_16x16x32_bf16 v[28:31], v[16:19], v[68:71], v[28:31]
  s_waitcnt vmcnt(4)
  buffer_load_dwordx4 v[92:95], v2, s[8:11], s20 offen offset:3072 nt
  s_add_u32 s30, s30, s21
  s_add_u32 s31, s31, 0x80000
  s_and_b32 s31, s31, 0x180000
  s_add_u32 s20, s30, s31
  v_mfma_f32_16x16x32_bf16 v[28:31], v[20:23], v[72:75], v[28:31]
  s_waitcnt vmcnt(4)
  buffer_load_dwordx4 v[64:67], v2, s[8:11], s20 offen offset:0 nt
  v_mfma_f32_16x16x32_bf16 v[28:31], v[24:27], v[76:79], v[28:31]
  s_waitcnt vmcnt(4)
  buffer_load_dwordx4 v[68:71], v2, s[8:11], s20 offen offset:1024 nt
  v_mfma_f32_16x16x32_bf16 v[32:35], v[12:15], v[80:83], 0
  s_nop 4
  v_mov_b32_dpp v43, v28 quad_perm:[0,0,0,0] row_mask:0xf bank_mask:0xf
  v_add_f32_dpp v43, v29, v43 quad_perm:[1,1,1,1] row_mask:0xf bank_mask:0xf
  v_add_f32_dpp v43, v30, v43 quad_perm:[2,2,2,2] row_mask:0xf bank_mask:0xf
  v_add_f32_dpp v43, v31, v43 quad_perm:[3,3,3,3] row_mask:0xf bank_mask:0xf
  v_cvt_pk_bf16_f32 v43, v43, v43
  v_lshlrev_b32 v43, 16, v43
  v_mul_f32 v43, s25, v43
  v_cvt_pk_bf16_f32 v43, v43, v43
  v_lshlrev_b32 v43, 16, v43
  ds_write_b32 v36, v43 offset:5120
  v_max_f32 v40, v40, v43
  s_waitcnt vmcnt(4)
  buffer_load_dwordx4 v[72:75], v2, s[8:11], s20 offen offset:2048 nt
  v_mfma_f32_16x16x32_bf16 v[32:35], v[16:19], v[84:87], v[32:35]
  s_waitcnt vmcnt(4)
  buffer_load_dwordx4 v[76:79], v2, s[8:11], s20 offen offset:3072 nt
  s_add_u32 s30, s30, s21
  s_add_u32 s31, s31, 0x80000
  s_and_b32 s31, s31, 0x180000
  s_add_u32 s20, s30, s31
  v_mfma_f32_16x16x32_bf16 v[32:35], v[20:23], v[88:91], v[32:35]
  s_waitcnt vmcnt(4)
  buffer_load_dwordx4 v[80:83], v2, s[8:11], s20 offen offset:0 nt
  v_mfma_f32_16x16x32_bf16 v[32:35], v[24:27], v[92:95], v[32:35]
  v_add_u32 v36, 512, v36
  s_sub_u32 s28, s28, 1
  s_cmp_lg_u32 s28, 0
  s_nop 4
  s_cbranch_scc1 L_loopK
  s_waitcnt vmcnt(4)
  buffer_load_dwordx4 v[84:87], v2, s[8:11], s20 offen offset:1024 nt
  v_mfma_f32_16x16x32_bf16 v[28:31], v[12:15], v[64:67], 0
  v_mov_b32_dpp v43, v32 quad_perm:[0,0,0,0] row_mask:0xf bank_mask:0xf
  v_add_f32_dpp v43, v33, v43 quad_perm:[1,1,1,1] row_mask:0xf bank_mask:0xf
  v_add_f32_dpp v43, v34, v43 quad_perm:[2,2,2,2] row_mask:0xf bank_mask:0xf
  v_add_f32_dpp v43, v35, v43 quad_perm:[3,3,3,3] row_mask:0xf bank_mask:0xf
  v_cvt_pk_bf16_f32 v43, v43, v43
  v_lshlrev_b32 v43, 16, v43
  v_mul_f32 v43, s25, v43
  v_cvt_pk_bf16_f32 v43, v43, v43
  v_lshlrev_b32 v43, 16, v43
  ds_write_b32 v36, v43 offset:4864
  v_max_f32 v40, v40, v43
  s_waitcnt vmcnt(4)
  buffer_load_dwordx4 v[88:91], v2, s[8:11], s20 offen offset:2048 nt
  v_mfma_f32_16x16x32_bf16 v[28:31], v[16:19], v[68:71], v[28:31]
  s_waitcnt vmcnt(4)
  buffer_load_dwordx4 v[92:95], v2, s[8:11], s20 offen offset:3072 nt
  s_add_u32 s30, s30, s21
  s_add_u32 s31, s31, 0x80000
  s_and_b32 s31, s31, 0x180000
  s_add_u32 s20, s30, s31
  v_mfma_f32_16x16x32_bf16 v[28:31], v[20:23], v[72:75], v[28:31]
  s_waitcnt vmcnt(4)
  buffer_load_dwordx4 v[64:67], v3, s[12:15], s23 offen offset:0 nt
  v_mfma_f32_16x16x32_bf16 v[28:31], v[24:27], v[76:79], v[28:31]
  s_waitcnt vmcnt(4)
  buffer_load_dwordx4 v[68:71], v3, s[12:15], s23 offen offset:1024 nt
  v_mfma_f32_16x16x32_bf16 v[32:35], v[12:15], v[80:83], 0
  s_nop 4
  v_mov_b32_dpp v43, v28 quad_perm:[0,0,0,0] row_mask:0xf bank_mask:0xf
  v_add_f32_dpp v43, v29, v43 quad_perm:[1,1,1,1] row_mask:0xf bank_mask:0xf
  v_add_f32_dpp v43, v30, v43 quad_perm:[2,2,2,2] row_mask:0xf bank_mask:0xf
  v_add_f32_dpp v43, v31, v43 quad_perm:[3,3,3,3] row_mask:0xf bank_mask:0xf
  v_cvt_pk_bf16_f32 v43, v43, v43
  v_lshlrev_b32 v43, 16, v43
  v_mul_f32 v43, s25, v43
  v_cvt_pk_bf16_f32 v43, v43, v43
  v_lshlrev_b32 v43, 16, v43
  ds_write_b32 v36, v43 offset:5120
  v_max_f32 v40, v40, v43
  s_waitcnt vmcnt(4)
  buffer_load_dwordx4 v[72:75], v3, s[12:15], s23 offen offset:2048 nt
  v_mfma_f32_16x16x32_bf16 v[32:35], v[16:19], v[84:87], v[32:35]
  s_waitcnt vmcnt(4)
  buffer_load_dwordx4 v[76:79], v3, s[12:15], s23 offen offset:3072 nt
  s_add_u32 s32, s32, s21
  s_add_u32 s33, s33, 0x80000
  s_and_b32 s33, s33, 0x180000
  s_add_u32 s23, s32, s33
  v_mfma_f32_16x16x32_bf16 v[32:35], v[20:23], v[88:91], v[32:35]
  s_waitcnt vmcnt(4)
  buffer_load_dwordx4 v[80:83], v3, s[12:15], s23 offen offset:0 nt
  v_mfma_f32_16x16x32_bf16 v[32:35], v[24:27], v[92:95], v[32:35]
  s_nop 7
  v_mov_b32_dpp v43, v32 quad_perm:[0,0,0,0] row_mask:0xf bank_mask:0xf
  v_add_f32_dpp v43, v33, v43 quad_perm:[1,1,1,1] row_mask:0xf bank_mask:0xf
  v_add_f32_dpp v43, v34, v43 quad_perm:[2,2,2,2] row_mask:0xf bank_mask:0xf
  v_add_f32_dpp v43, v35, v43 quad_perm:[3,3,3,3] row_mask:0xf bank_mask:0xf
  v_cvt_pk_bf16_f32 v43, v43, v43
  v_lshlrev_b32 v43, 16, v43
  v_mul_f32 v43, s25, v43
  v_cvt_pk_bf16_f32 v43, v43, v43
  v_lshlrev_b32 v43, 16, v43
  ds_write_b32 v36, v43 offset:5376
  v_max_f32 v40, v40, v43
  ds_read_b32 v38, v37 offset:0
  s_nop 0
  v_max_f32_dpp v40, v40, v40 row_ror:4 row_mask:0xf bank_mask:0xf
  s_nop 1
  v_max_f32_dpp v40, v40, v40 row_ror:8 row_mask:0xf bank_mask:0xf
  v_mov_b32 v43, v40
  s_nop 1
  v_permlane16_swap_b32 v43, v40
  v_max_f32 v40, v40, v43
  v_mov_b32 v43, v40
  s_nop 1
  v_permlane32_swap_b32 v43, v40
  v_max_f32 v40, v40, v43
  v_mul_f32 v41, s24, v40
  v_mov_b32 v42, 0
  v_mov_b32 v56, 0
  v_mov_b32 v57, 0
  v_mov_b32 v58, 0
  v_mov_b32 v59, 0
  s_waitcnt vmcnt(4)
  buffer_load_dwordx4 v[84:87], v3, s[12:15], s23 offen offset:1024 nt
  s_waitcnt lgkmcnt(0)
  ds_read_b32 v39, v37 offset:256
  v_fma_f32 v43, v38, s24, -v41
  v_exp_f32 v44, v43
  s_nop 0
  v_add_f32 v42, v42, v44
  v_cvt_pk_bf16_f32 v45, v44, v44
  s_nop 1
  v_and_b32_dpp v48, v45, v8 row_newbcast:0 row_mask:0xf bank_mask:0xf
  v_and_b32_dpp v49, v45, v9 row_newbcast:0 row_mask:0xf bank_mask:0xf
  v_and_b32_dpp v50, v45, v10 row_newbcast:0 row_mask:0xf bank_mask:0xf
  v_and_b32_dpp v51, v45, v11 row_newbcast:0 row_mask:0xf bank_mask:0xf
  s_nop 1
  v_mfma_f32_16x16x32_bf16 v[56:59], v[64:67], v[48:51], v[56:59]
  s_waitcnt vmcnt(4)
  buffer_load_dwordx4 v[88:91], v3, s[12:15], s23 offen offset:2048 nt
  v_and_b32_dpp v52, v45, v8 row_newbcast:4 row_mask:0xf bank_mask:0xf
  v_and_b32_dpp v53, v45, v9 row_newbcast:4 row_mask:0xf bank_mask:0xf
  v_and_b32_dpp v54, v45, v10 row_newbcast:4 row_mask:0xf bank_mask:0xf
  v_and_b32_dpp v55, v45, v11 row_newbcast:4 row_mask:0xf bank_mask:0xf
  s_nop 1
  v_mfma_f32_16x16x32_bf16 v[56:59], v[68:71], v[52:55], v[56:59]
  s_waitcnt vmcnt(4)
  buffer_load_dwordx4 v[92:95], v3, s[12:15], s23 offen offset:3072 nt
  s_add_u32 s32, s32, s21
  s_add_u32 s33, s33, 0x80000
  s_and_b32 s33, s33, 0x180000
  s_add_u32 s23, s32, s33
  v_and_b32_dpp v48, v45, v8 row_newbcast:8 row_mask:0xf bank_mask:0xf
  v_and_b32_dpp v49, v45, v9 row_newbcast:8 row_mask:0xf bank_mask:0xf
  v_and_b32_dpp v50, v45, v10 row_newbcast:8 row_mask:0xf bank_mask:0xf
  v_and_b32_dpp v51, v45, v11 row_newbcast:8 row_mask:0xf bank_mask:0xf
  s_nop 1
  v_mfma_f32_16x16x32_bf16 v[56:59], v[72:75], v[48:51], v[56:59]
  s_waitcnt vmcnt(4)
  buffer_load_dwordx4 v[64:67], v3, s[12:15], s23 offen offset:0 nt
  v_and_b32_dpp v52, v45, v8 row_newbcast:12 row_mask:0xf bank_mask:0xf
  v_and_b32_dpp v53, v45, v9 row_newbcast:12 row_mask:0xf bank_mask:0xf
  v_and_b32_dpp v54, v45, v10 row_newbcast:12 row_mask:0xf bank_mask:0xf
  v_and_b32_dpp v55, v45, v11 row_newbcast:12 row_mask:0xf bank_mask:0xf
  s_nop 1
  v_mfma_f32_16x16x32_bf16 v[56:59], v[76:79], v[52:55], v[56:59]
  s_waitcnt vmcnt(4)
  buffer_load_dwordx4 v[68:71], v3, s[12:15], s23 offen offset:1024 nt
  s_waitcnt lgkmcnt(0)
  ds_read_b32 v38, v37 offset:512
  v_fma_f32 v43, v39, s24, -v41
  v_exp_f32 v44, v43
  s_nop 0
  v_add_f32 v42, v42, v44
  v_cvt_pk_bf16_f32 v46, v44, v44
  s_nop 1
  v_and_b32_dpp v48, v46, v8 row_newbcast:0 row_mask:0xf bank_mask:0xf
  v_and_b32_dpp v49, v46, v9 row_newbcast:0 row_mask:0xf bank_mask:0xf
  v_and_b32_dpp v50, v46, v10 row_newbcast:0 row_mask:0xf bank_mask:0xf
  v_and_b32_dpp v51, v46, v11 row_newbcast:0 row_mask:0xf bank_mask:0xf
  s_nop 1
  v_mfma_f32_16x16x32_bf16 v[56:59], v[80:83], v[48:51], v[56:59]
  s_waitcnt vmcnt(4)
  buffer_load_dwordx4 v[72:75], v3, s[12:15], s23 offen offset:2048 nt
  v_and_b32_dpp v52, v46, v8 row_newbcast:4 row_mask:0xf bank_mask:0xf
  v_and_b32_dpp v53, v46, v9 row_newbcast:4 row_mask:0xf bank_mask:0xf
  v_and_b32_dpp v54, v46, v10 row_newbcast:4 row_mask:0xf bank_mask:0xf
  v_and_b32_dpp v55, v46, v11 row_newbcast:4 row_mask:0xf bank_mask:0xf
  s_nop 1
  v_mfma_f32_16x16x32_bf16 v[56:59], v[84:87], v[52:55], v[56:59]
  s_waitcnt vmcnt(4)
  buffer_load_dwordx4 v[76:79], v3, s[12:15], s23 offen offset:3072 nt
  s_add_u32 s32, s32, s21
  s_add_u32 s33, s33, 0x80000
  s_and_b32 s33, s33, 0x180000
  s_add_u32 s23, s32, s33
  v_and_b32_dpp v48, v46, v8 row_newbcast:8 row_mask:0xf bank_mask:0xf
  v_and_b32_dpp v49, v46, v9 row_newbcast:8 row_mask:0xf bank_mask:0xf
  v_and_b32_dpp v50, v46, v10 row_newbcast:8 row_mask:0xf bank_mask:0xf
  v_and_b32_dpp v51, v46, v11 row_newbcast:8 row_mask:0xf bank_mask:0xf
  s_nop 1
  v_mfma_f32_16x16x32_bf16 v[56:59], v[88:91], v[48:51], v[56:59]
  s_waitcnt vmcnt(4)
  buffer_load_dwordx4 v[80:83], v3, s[12:15], s23 offen offset:0 nt
  v_and_b32_dpp v52, v46, v8 row_newbcast:12 row_mask:0xf bank_mask:0xf
  v_and_b32_dpp v53, v46, v9 row_newbcast:12 row_mask:0xf bank_mask:0xf
  v_and_b32_dpp v54, v46, v10 row_newbcast:12 row_mask:0xf bank_mask:0xf
  v_and_b32_dpp v55, v46, v11 row_newbcast:12 row_mask:0xf bank_mask:0xf
  s_nop 1
  v_mfma_f32_16x16x32_bf16 v[56:59], v[92:95], v[52:55], v[56:59]
  s_mov_b32 s28, 11
  s_nop 6
L_loopV:
  s_waitcnt vmcnt(4)
  buffer_load_dwordx4 v[84:87], v3, s[12:15], s23 offen offset:1024 nt
  s_waitcnt lgkmcnt(0)
  ds_read_b32 v39, v37 offset:768
  v_fma_f32 v43, v38, s24, -v41
  v_exp_f32 v44, v43
  s_nop 0
  v_add_f32 v42, v42, v44
  v_cvt_pk_bf16_f32 v45, v44, v44
  s_nop 1
  v_and_b32_dpp v48, v45, v8 row_newbcast:0 row_mask:0xf bank_mask:0xf
  v_and_b32_dpp v49, v45, v9 row_newbcast:0 row_mask:0xf bank_mask:0xf
  v_and_b32_dpp v50, v45, v10 row_newbcast:0 row_mask:0xf bank_mask:0xf
  v_and_b32_dpp v51, v45, v11 row_newbcast:0 row_mask:0xf bank_mask:0xf
  s_nop 1
  v_mfma_f32_16x16x32_bf16 v[56:59], v[64:67], v[48:51], v[56:59]
  s_waitcnt vmcnt(4)
  buffer_load_dwordx4 v[88:91], v3, s[12:15], s23 offen offset:2048 nt
  v_and_b32_dpp v52, v45, v8 row_newbcast:4 row_mask:0xf bank_mask:0xf
  v_and_b32_dpp v53, v45, v9 row_newbcast:4 row_mask:0xf bank_mask:0xf
  v_and_b32_dpp v54, v45, v10 row_newbcast:4 row_mask:0xf bank_mask:0xf
  v_and_b32_dpp v55, v45, v11 row_newbcast:4 row_mask:0xf bank_mask:0xf
  s_nop 1
  v_mfma_f32_16x16x32_bf16 v[56:59], v[68:71], v[52:55], v[56:59]
  s_waitcnt vmcnt(4)
  buffer_load_dwordx4 v[92:95], v3, s[12:15], s23 offen offset:3072 nt
  s_add_u32 s32, s32, s21
  s_add_u32 s33, s33, 0x80000
  s_and_b32 s33, s33, 0x180000
  s_add_u32 s23, s32, s33
  v_and_b32_dpp v48, v45, v8 row_newbcast:8 row_mask:0xf bank_mask:0xf
  v_and_b32_dpp v49, v45, v9 row_newbcast:8 row_mask:0xf bank_mask:0xf
  v_and_b32_dpp v50, v45, v10 row_newbcast:8 row_mask:0xf bank_mask:0xf
  v_and_b32_dpp v51, v45, v11 row_newbcast:8 row_mask:0xf bank_mask:0xf
  s_nop 1
  v_mfma_f32_16x16x32_bf16 v[56:59], v[72:75], v[48:51], v[56:59]
  s_waitcnt vmcnt(4)
  buffer_load_dwordx4 v[64:67], v3, s[12:15], s23 offen offset:0 nt
  v_and_b32_dpp v52, v45, v8 row_newbcast:12 row_mask:0xf bank_mask:0xf
  v_and_b32_dpp v53, v45, v9 row_newbcast:12 row_mask:0xf bank_mask:0xf
  v_and_b32_dpp v54, v45, v10 row_newbcast:12 row_mask:0xf bank_mask:0xf
  v_and_b32_dpp v55, v45, v11 row_newbcast:12 row_mask:0xf bank_mask:0xf
  s_nop 1
  v_mfma_f32_16x16x32_bf16 v[56:59], v[76:79], v[52:55], v[56:59]
  s_waitcnt vmcnt(4)
  buffer_load_dwordx4 v[68:71], v3, s[12:15], s23 offen offset:1024 nt
  s_waitcnt lgkmcnt(0)
  ds_read_b32 v38, v37 offset:1024
  v_fma_f32 v43, v39, s24, -v41
  v_exp_f32 v44, v43
  s_nop 0
  v_add_f32 v42, v42, v44
  v_cvt_pk_bf16_f32 v46, v44, v44
  s_nop 1
  v_and_b32_dpp v48, v46, v8 row_newbcast:0 row_mask:0xf bank_mask:0xf
  v_and_b32_dpp v49, v46, v9 row_newbcast:0 row_mask:0xf bank_mask:0xf
  v_and_b32_dpp v50, v46, v10 row_newbcast:0 row_mask:0xf bank_mask:0xf
  v_and_b32_dpp v51, v46, v11 row_newbcast:0 row_mask:0xf bank_mask:0xf
  s_nop 1
  v_mfma_f32_16x16x32_bf16 v[56:59], v[80:83], v[48:51], v[56:59]
  s_waitcnt vmcnt(4)
  buffer_load_dwordx4 v[72:75], v3, s[12:15], s23 offen offset:2048 nt
  v_and_b32_dpp v52, v46, v8 row_newbcast:4 row_mask:0xf bank_mask:0xf
  v_and_b32_dpp v53, v46, v9 row_newbcast:4 row_mask:0xf bank_mask:0xf
  v_and_b32_dpp v54, v46, v10 row_newbcast:4 row_mask:0xf bank_mask:0xf
  v_and_b32_dpp v55, v46, v11 row_newbcast:4 row_mask:0xf bank_mask:0xf
  s_nop 1
  v_mfma_f32_16x16x32_bf16 v[56:59], v[84:87], v[52:55], v[56:59]
  s_waitcnt vmcnt(4)
  buffer_load_dwordx4 v[76:79], v3, s[12:15], s23 offen offset:3072 nt
  s_add_u32 s32, s32, s21
  s_add_u32 s33, s33, 0x80000
  s_and_b32 s33, s33, 0x180000
  s_add_u32 s23, s32, s33
  v_and_b32_dpp v48, v46, v8 row_newbcast:8 row_mask:0xf bank_mask:0xf
  v_and_b32_dpp v49, v46, v9 row_newbcast:8 row_mask:0xf bank_mask:0xf
  v_and_b32_dpp v50, v46, v10 row_newbcast:8 row_mask:0xf bank_mask:0xf
  v_and_b32_dpp v51, v46, v11 row_newbcast:8 row_mask:0xf bank_mask:0xf
  s_nop 1
  v_mfma_f32_16x16x32_bf16 v[56:59], v[88:91], v[48:51], v[56:59]
  s_waitcnt vmcnt(4)
  buffer_load_dwordx4 v[80:83], v3, s[12:15], s23 offen offset:0 nt
  v_and_b32_dpp v52, v46, v8 row_newbcast:12 row_mask:0xf bank_mask:0xf
  v_and_b32_dpp v53, v46, v9 row_newbcast:12 row_mask:0xf bank_mask:0xf
  v_and_b32_dpp v54, v46, v10 row_newbcast:12 row_mask:0xf bank_mask:0xf
  v_and_b32_dpp v55, v46, v11 row_newbcast:12 row_mask:0xf bank_mask:0xf
  s_nop 1
  v_mfma_f32_16x16x32_bf16 v[56:59], v[92:95], v[52:55], v[56:59]
  v_add_u32 v37, 512, v37
  s_sub_u32 s28, s28, 1
  s_cmp_lg_u32 s28, 0
  s_nop 4
  s_cbranch_scc1 L_loopV
  s_waitcnt vmcnt(4)
  buffer_load_dwordx4 v[84:87], v3, s[12:15], s23 offen offset:1024 nt
  s_waitcnt lgkmcnt(0)
  ds_read_b32 v39, v37 offset:768
  v_fma_f32 v43, v38, s24, -v41
  v_exp_f32 v44, v43
  s_nop 0
  v_add_f32 v42, v42, v44
  v_cvt_pk_bf16_f32 v45, v44, v44
  s_nop 1
  v_and_b32_dpp v48, v45, v8 row_newbcast:0 row_mask:0xf bank_mask:0xf
  v_and_b32_dpp v49, v45, v9 row_newbcast:0 row_mask:0xf bank_mask:0xf
  v_and_b32_dpp v50, v45, v10 row_newbcast:0 row_mask:0xf bank_mask:0xf
  v_and_b32_dpp v51, v45, v11 row_newbcast:0 row_mask:0xf bank_mask:0xf
  s_nop 1
  v_mfma_f32_16x16x32_bf16 v[56:59], v[64:67], v[48:51], v[56:59]
  s_waitcnt vmcnt(4)
  buffer_load_dwordx4 v[88:91], v3, s[12:15], s23 offen offset:2048 nt
  v_and_b32_dpp v52, v45, v8 row_newbcast:4 row_mask:0xf bank_mask:0xf
  v_and_b32_dpp v53, v45, v9 row_newbcast:4 row_mask:0xf bank_mask:0xf
  v_and_b32_dpp v54, v45, v10 row_newbcast:4 row_mask:0xf bank_mask:0xf
  v_and_b32_dpp v55, v45, v11 row_newbcast:4 row_mask:0xf bank_mask:0xf
  s_nop 1
  v_mfma_f32_16x16x32_bf16 v[56:59], v[68:71], v[52:55], v[56:59]
  s_waitcnt vmcnt(4)
  buffer_load_dwordx4 v[92:95], v3, s[12:15], s23 offen offset:3072 nt
  s_add_u32 s32, s32, s21
  s_add_u32 s33, s33, 0x80000
  s_and_b32 s33, s33, 0x180000
  s_add_u32 s23, s32, s33
  buffer_load_dwordx4 v[96:99], v3, s[12:15], s23 offen offset:0 nt
  buffer_load_dwordx4 v[100:103], v3, s[12:15], s23 offen offset:1024 nt
  v_and_b32_dpp v48, v45, v8 row_newbcast:8 row_mask:0xf bank_mask:0xf
  v_and_b32_dpp v49, v45, v9 row_newbcast:8 row_mask:0xf bank_mask:0xf
  v_and_b32_dpp v50, v45, v10 row_newbcast:8 row_mask:0xf bank_mask:0xf
  v_and_b32_dpp v51, v45, v11 row_newbcast:8 row_mask:0xf bank_mask:0xf
  s_nop 1
  v_mfma_f32_16x16x32_bf16 v[56:59], v[72:75], v[48:51], v[56:59]
  s_waitcnt vmcnt(6)
  buffer_load_dwordx4 v[104:107], v3, s[12:15], s23 offen offset:2048 nt
  v_and_b32_dpp v52, v45, v8 row_newbcast:12 row_mask:0xf bank_mask:0xf
  v_and_b32_dpp v53, v45, v9 row_newbcast:12 row_mask:0xf bank_mask:0xf
  v_and_b32_dpp v54, v45, v10 row_newbcast:12 row_mask:0xf bank_mask:0xf
  v_and_b32_dpp v55, v45, v11 row_newbcast:12 row_mask:0xf bank_mask:0xf
  s_nop 1
  v_mfma_f32_16x16x32_bf16 v[56:59], v[76:79], v[52:55], v[56:59]
  s_waitcnt vmcnt(6)
  buffer_load_dwordx4 v[108:111], v3, s[12:15], s23 offen offset:3072 nt
  s_add_u32 s32, s32, s21
  s_add_u32 s33, s33, 0x80000
  s_and_b32 s33, s33, 0x180000
  s_add_u32 s23, s32, s33
  s_waitcnt lgkmcnt(0)
  ds_read_b32 v38, v37 offset:1024
  v_fma_f32 v43, v39, s24, -v41
  v_exp_f32 v44, v43
  s_nop 0
  v_add_f32 v42, v42, v44
  v_cvt_pk_bf16_f32 v46, v44, v44
  s_nop 1
  v_and_b32_dpp v48, v46, v8 row_newbcast:0 row_mask:0xf bank_mask:0xf
  v_and_b32_dpp v49, v46, v9 row_newbcast:0 row_mask:0xf bank_mask:0xf
  v_and_b32_dpp v50, v46, v10 row_newbcast:0 row_mask:0xf bank_mask:0xf
  v_and_b32_dpp v51, v46, v11 row_newbcast:0 row_mask:0xf bank_mask:0xf
  s_nop 1
  v_mfma_f32_16x16x32_bf16 v[56:59], v[80:83], v[48:51], v[56:59]
  s_waitcnt vmcnt(6)
  buffer_load_dwordx4 v[112:115], v3, s[12:15], s23 offen offset:0 nt
  v_and_b32_dpp v52, v46, v8 row_newbcast:4 row_mask:0xf bank_mask:0xf
  v_and_b32_dpp v53, v46, v9 row_newbcast:4 row_mask:0xf bank_mask:0xf
  v_and_b32_dpp v54, v46, v10 row_newbcast:4 row_mask:0xf bank_mask:0xf
  v_and_b32_dpp v55, v46, v11 row_newbcast:4 row_mask:0xf bank_mask:0xf
  s_nop 1
  v_mfma_f32_16x16x32_bf16 v[56:59], v[84:87], v[52:55], v[56:59]
  s_waitcnt vmcnt(6)
  buffer_load_dwordx4 v[116:119], v3, s[12:15], s23 offen offset:1024 nt
  v_and_b32_dpp v48, v46, v8 row_newbcast:8 row_mask:0xf bank_mask:0xf
  v_and_b32_dpp v49, v46, v9 row_newbcast:8 row_mask:0xf bank_mask:0xf
  v_and_b32_dpp v50, v46, v10 row_newbcast:8 row_mask:0xf bank_mask:0xf
  v_and_b32_dpp v51, v46, v11 row_newbcast:8 row_mask:0xf bank_mask:0xf
  s_nop 1
  v_mfma_f32_16x16x32_bf16 v[56:59], v[88:91], v[48:51], v[56:59]
  s_waitcnt vmcnt(6)
  buffer_load_dwordx4 v[120:123], v3, s[12:15], s23 offen offset:2048 nt
  v_and_b32_dpp v52, v46, v8 row_newbcast:12 row_mask:0xf bank_mask:0xf
  v_and_b32_dpp v53, v46, v9 row_newbcast:12 row_mask:0xf bank_mask:0xf
  v_and_b32_dpp v54, v46, v10 row_newbcast:12 row_mask:0xf bank_mask:0xf
  v_and_b32_dpp v55, v46, v11 row_newbcast:12 row_mask:0xf bank_mask:0xf
  s_nop 1
  v_mfma_f32_16x16x32_bf16 v[56:59], v[92:95], v[52:55], v[56:59]
  s_waitcnt vmcnt(6)
  buffer_load_dwordx4 v[124:127], v3, s[12:15], s23 offen offset:3072 nt
  s_add_u32 s32, s32, s21
  s_add_u32 s33, s33, 0x80000
  s_and_b32 s33, s33, 0x180000
  s_add_u32 s23, s32, s33
  s_waitcnt lgkmcnt(0)
  ds_read_b32 v39, v37 offset:1280
  v_fma_f32 v43, v38, s24, -v41
  v_exp_f32 v44, v43
  s_nop 0
  v_add_f32 v42, v42, v44
  v_cvt_pk_bf16_f32 v45, v44, v44
  s_nop 1
  v_and_b32_dpp v48, v45, v8 row_newbcast:0 row_mask:0xf bank_mask:0xf
  v_and_b32_dpp v49, v45, v9 row_newbcast:0 row_mask:0xf bank_mask:0xf
  v_and_b32_dpp v50, v45, v10 row_newbcast:0 row_mask:0xf bank_mask:0xf
  v_and_b32_dpp v51, v45, v11 row_newbcast:0 row_mask:0xf bank_mask:0xf
  s_nop 1
  v_mfma_f32_16x16x32_bf16 v[56:59], v[96:99], v[48:51], v[56:59]
  s_waitcnt vmcnt(6)
  buffer_load_dwordx4 v[96:99], v3, s[12:15], s23 offen offset:0 nt
  v_and_b32_dpp v52, v45, v8 row_newbcast:4 row_mask:0xf bank_mask:0xf
  v_and_b32_dpp v53, v45, v9 row_newbcast:4 row_mask:0xf bank_mask:0xf
  v_and_b32_dpp v54, v45, v10 row_newbcast:4 row_mask:0xf bank_mask:0xf
  v_and_b32_dpp v55, v45, v11 row_newbcast:4 row_mask:0xf bank_mask:0xf
  s_nop 1
  v_mfma_f32_16x16x32_bf16 v[56:59], v[100:103], v[52:55], v[56:59]
  s_waitcnt vmcnt(6)
  buffer_load_dwordx4 v[100:103], v3, s[12:15], s23 offen offset:1024 nt
  v_and_b32_dpp v48, v45, v8 row_newbcast:8 row_mask:0xf bank_mask:0xf
  v_and_b32_dpp v49, v45, v9 row_newbcast:8 row_mask:0xf bank_mask:0xf
  v_and_b32_dpp v50, v45, v10 row_newbcast:8 row_mask:0xf bank_mask:0xf
  v_and_b32_dpp v51, v45, v11 row_newbcast:8 row_mask:0xf bank_mask:0xf
  s_nop 1
  v_mfma_f32_16x16x32_bf16 v[56:59], v[104:107], v[48:51], v[56:59]
  s_waitcnt vmcnt(6)
  buffer_load_dwordx4 v[104:107], v3, s[12:15], s23 offen offset:2048 nt
  v_and_b32_dpp v52, v45, v8 row_newbcast:12 row_mask:0xf bank_mask:0xf
  v_and_b32_dpp v53, v45, v9 row_newbcast:12 row_mask:0xf bank_mask:0xf
  v_and_b32_dpp v54, v45, v10 row_newbcast:12 row_mask:0xf bank_mask:0xf
  v_and_b32_dpp v55, v45, v11 row_newbcast:12 row_mask:0xf bank_mask:0xf
  s_nop 1
  v_mfma_f32_16x16x32_bf16 v[56:59], v[108:111], v[52:55], v[56:59]
  s_waitcnt vmcnt(6)
  buffer_load_dwordx4 v[108:111], v3, s[12:15], s23 offen offset:3072 nt
  s_add_u32 s32, s32, s21
  s_add_u32 s33, s33, 0x80000
  s_and_b32 s33, s33, 0x180000
  s_add_u32 s23, s32, s33
  s_waitcnt lgkmcnt(0)
  ds_read_b32 v38, v37 offset:1536
  v_fma_f32 v43, v39, s24, -v41
  v_exp_f32 v44, v43
  s_nop 0
  v_add_f32 v42, v42, v44
  v_cvt_pk_bf16_f32 v46, v44, v44
  s_nop 1
  v_and_b32_dpp v48, v46, v8 row_newbcast:0 row_mask:0xf bank_mask:0xf
  v_and_b32_dpp v49, v46, v9 row_newbcast:0 row_mask:0xf bank_mask:0xf
  v_and_b32_dpp v50, v46, v10 row_newbcast:0 row_mask:0xf bank_mask:0xf
  v_and_b32_dpp v51, v46, v11 row_newbcast:0 row_mask:0xf bank_mask:0xf
  s_nop 1
  v_mfma_f32_16x16x32_bf16 v[56:59], v[112:115], v[48:51], v[56:59]
  s_waitcnt vmcnt(6)
  buffer_load_dwordx4 v[112:115], v3, s[12:15], s23 offen offset:0 nt
  v_and_b32_dpp v52, v46, v8 row_newbcast:4 row_mask:0xf bank_mask:0xf
  v_and_b32_dpp v53, v46, v9 row_newbcast:4 row_mask:0xf bank_mask:0xf
  v_and_b32_dpp v54, v46, v10 row_newbcast:4 row_mask:0xf bank_mask:0xf
  v_and_b32_dpp v55, v46, v11 row_newbcast:4 row_mask:0xf bank_mask:0xf
  s_nop 1
  v_mfma_f32_16x16x32_bf16 v[56:59], v[116:119], v[52:55], v[56:59]
  s_waitcnt vmcnt(6)
  buffer_load_dwordx4 v[116:119], v3, s[12:15], s23 offen offset:1024 nt
  v_and_b32_dpp v48, v46, v8 row_newbcast:8 row_mask:0xf bank_mask:0xf
  v_and_b32_dpp v49, v46, v9 row_newbcast:8 row_mask:0xf bank_mask:0xf
  v_and_b32_dpp v50, v46, v10 row_newbcast:8 row_mask:0xf bank_mask:0xf
  v_and_b32_dpp v51, v46, v11 row_newbcast:8 row_mask:0xf bank_mask:0xf
  s_nop 1
  v_mfma_f32_16x16x32_bf16 v[56:59], v[120:123], v[48:51], v[56:59]
  s_waitcnt vmcnt(6)
  buffer_load_dwordx4 v[120:123], v3, s[12:15], s23 offen offset:2048 nt
  v_and_b32_dpp v52, v46, v8 row_newbcast:12 row_mask:0xf bank_mask:0xf
  v_and_b32_dpp v53, v46, v9 row_newbcast:12 row_mask:0xf bank_mask:0xf
  v_and_b32_dpp v54, v46, v10 row_newbcast:12 row_mask:0xf bank_mask:0xf
  v_and_b32_dpp v55, v46, v11 row_newbcast:12 row_mask:0xf bank_mask:0xf
  s_nop 1
  v_mfma_f32_16x16x32_bf16 v[56:59], v[124:127], v[52:55], v[56:59]
  s_waitcnt vmcnt(6)
  buffer_load_dwordx4 v[124:127], v3, s[12:15], s23 offen offset:3072 nt
  s_add_u32 s32, s32, s21
  s_add_u32 s33, s33, 0x80000
  s_and_b32 s33, s33, 0x180000
  s_add_u32 s23, s32, s33
  s_waitcnt lgkmcnt(0)
  ds_read_b32 v39, v37 offset:1792
  v_fma_f32 v43, v38, s24, -v41
  v_exp_f32 v44, v43
  s_nop 0
  v_add_f32 v42, v42, v44
  v_cvt_pk_bf16_f32 v45, v44, v44
  s_nop 1
  v_and_b32_dpp v48, v45, v8 row_newbcast:0 row_mask:0xf bank_mask:0xf
  v_and_b32_dpp v49, v45, v9 row_newbcast:0 row_mask:0xf bank_mask:0xf
  v_and_b32_dpp v50, v45, v10 row_newbcast:0 row_mask:0xf bank_mask:0xf
  v_and_b32_dpp v51, v45, v11 row_newbcast:0 row_mask:0xf bank_mask:0xf
  s_nop 1
  v_mfma_f32_16x16x32_bf16 v[56:59], v[96:99], v[48:51], v[56:59]
  s_waitcnt vmcnt(6)
  buffer_load_dwordx4 v[96:99], v3, s[12:15], s23 offen offset:0 nt
  v_and_b32_dpp v52, v45, v8 row_newbcast:4 row_mask:0xf bank_mask:0xf
  v_and_b32_dpp v53, v45, v9 row_newbcast:4 row_mask:0xf bank_mask:0xf
  v_and_b32_dpp v54, v45, v10 row_newbcast:4 row_mask:0xf bank_mask:0xf
  v_and_b32_dpp v55, v45, v11 row_newbcast:4 row_mask:0xf bank_mask:0xf
  s_nop 1
  v_mfma_f32_16x16x32_bf16 v[56:59], v[100:103], v[52:55], v[56:59]
  s_waitcnt vmcnt(6)
  buffer_load_dwordx4 v[100:103], v3, s[12:15], s23 offen offset:1024 nt
  v_and_b32_dpp v48, v45, v8 row_newbcast:8 row_mask:0xf bank_mask:0xf
  v_and_b32_dpp v49, v45, v9 row_newbcast:8 row_mask:0xf bank_mask:0xf
  v_and_b32_dpp v50, v45, v10 row_newbcast:8 row_mask:0xf bank_mask:0xf
  v_and_b32_dpp v51, v45, v11 row_newbcast:8 row_mask:0xf bank_mask:0xf
  s_nop 1
  v_mfma_f32_16x16x32_bf16 v[56:59], v[104:107], v[48:51], v[56:59]
  s_waitcnt vmcnt(6)
  buffer_load_dwordx4 v[104:107], v3, s[12:15], s23 offen offset:2048 nt
  v_and_b32_dpp v52, v45, v8 row_newbcast:12 row_mask:0xf bank_mask:0xf
  v_and_b32_dpp v53, v45, v9 row_newbcast:12 row_mask:0xf bank_mask:0xf
  v_and_b32_dpp v54, v45, v10 row_newbcast:12 row_mask:0xf bank_mask:0xf
  v_and_b32_dpp v55, v45, v11 row_newbcast:12 row_mask:0xf bank_mask:0xf
  s_nop 1
  v_mfma_f32_16x16x32_bf16 v[56:59], v[108:111], v[52:55], v[56:59]
  s_waitcnt vmcnt(6)
  buffer_load_dwordx4 v[108:111], v3, s[12:15], s23 offen offset:3072 nt
  s_add_u32 s32, s32, s21
  s_add_u32 s33, s33, 0x80000
  s_and_b32 s33, s33, 0x180000
  s_add_u32 s23, s32, s33
  s_waitcnt lgkmcnt(0)
  ds_read_b32 v38, v37 offset:2048
  v_fma_f32 v43, v39, s24, -v41
  v_exp_f32 v44, v43
  s_nop 0
  v_add_f32 v42, v42, v44
  v_cvt_pk_bf16_f32 v46, v44, v44
  s_nop 1
  v_and_b32_dpp v48, v46, v8 row_newbcast:0 row_mask:0xf bank_mask:0xf
  v_and_b32_dpp v49, v46, v9 row_newbcast:0 row_mask:0xf bank_mask:0xf
  v_and_b32_dpp v50, v46, v10 row_newbcast:0 row_mask:0xf bank_mask:0xf
  v_and_b32_dpp v51, v46, v11 row_newbcast:0 row_mask:0xf bank_mask:0xf
  s_nop 1
  v_mfma_f32_16x16x32_bf16 v[56:59], v[112:115], v[48:51], v[56:59]
  s_waitcnt vmcnt(6)
  buffer_load_dwordx4 v[112:115], v3, s[12:15], s23 offen offset:0 nt
  v_and_b32_dpp v52, v46, v8 row_newbcast:4 row_mask:0xf bank_mask:0xf
  v_and_b32_dpp v53, v46, v9 row_newbcast:4 row_mask:0xf bank_mask:0xf
  v_and_b32_dpp v54, v46, v10 row_newbcast:4 row_mask:0xf bank_mask:0xf
  v_and_b32_dpp v55, v46, v11 row_newbcast:4 row_mask:0xf bank_mask:0xf
  s_nop 1
  v_mfma_f32_16x16x32_bf16 v[56:59], v[116:119], v[52:55], v[56:59]
  s_waitcnt vmcnt(6)
  buffer_load_dwordx4 v[116:119], v3, s[12:15], s23 offen offset:1024 nt
  v_and_b32_dpp v48, v46, v8 row_newbcast:8 row_mask:0xf bank_mask:0xf
  v_and_b32_dpp v49, v46, v9 row_newbcast:8 row_mask:0xf bank_mask:0xf
  v_and_b32_dpp v50, v46, v10 row_newbcast:8 row_mask:0xf bank_mask:0xf
  v_and_b32_dpp v51, v46, v11 row_newbcast:8 row_mask:0xf bank_mask:0xf
  s_nop 1
  v_mfma_f32_16x16x32_bf16 v[56:59], v[120:123], v[48:51], v[56:59]
  s_waitcnt vmcnt(6)
  buffer_load_dwordx4 v[120:123], v3, s[12:15], s23 offen offset:2048 nt
  v_and_b32_dpp v52, v46, v8 row_newbcast:12 row_mask:0xf bank_mask:0xf
  v_and_b32_dpp v53, v46, v9 row_newbcast:12 row_mask:0xf bank_mask:0xf
  v_and_b32_dpp v54, v46, v10 row_newbcast:12 row_mask:0xf bank_mask:0xf
  v_and_b32_dpp v55, v46, v11 row_newbcast:12 row_mask:0xf bank_mask:0xf
  s_nop 1
  v_mfma_f32_16x16x32_bf16 v[56:59], v[124:127], v[52:55], v[56:59]
  s_waitcnt vmcnt(6)
  buffer_load_dwordx4 v[124:127], v3, s[12:15], s23 offen offset:3072 nt
  s_add_u32 s32, s32, s21
  s_add_u32 s33, s33, 0x80000
  s_and_b32 s33, s33, 0x180000
  s_add_u32 s23, s32, s33
  s_waitcnt lgkmcnt(0)
  ds_read_b32 v39, v37 offset:2304
  v_fma_f32 v43, v38, s24, -v41
  v_exp_f32 v44, v43
  s_nop 0
  v_add_f32 v42, v42, v44
  v_cvt_pk_bf16_f32 v45, v44, v44
  s_nop 1
  v_and_b32_dpp v48, v45, v8 row_newbcast:0 row_mask:0xf bank_mask:0xf
  v_and_b32_dpp v49, v45, v9 row_newbcast:0 row_mask:0xf bank_mask:0xf
  v_and_b32_dpp v50, v45, v10 row_newbcast:0 row_mask:0xf bank_mask:0xf
  v_and_b32_dpp v51, v45, v11 row_newbcast:0 row_mask:0xf bank_mask:0xf
  s_nop 1
  v_mfma_f32_16x16x32_bf16 v[56:59], v[96:99], v[48:51], v[56:59]
  s_waitcnt vmcnt(6)
  v_and_b32_dpp v52, v45, v8 row_newbcast:4 row_mask:0xf bank_mask:0xf
  v_and_b32_dpp v53, v45, v9 row_newbcast:4 row_mask:0xf bank_mask:0xf
  v_and_b32_dpp v54, v45, v10 row_newbcast:4 row_mask:0xf bank_mask:0xf
  v_and_b32_dpp v55, v45, v11 row_newbcast:4 row_mask:0xf bank_mask:0xf
  s_nop 1
  v_mfma_f32_16x16x32_bf16 v[56:59], v[100:103], v[52:55], v[56:59]
  s_waitcnt vmcnt(5)
  v_and_b32_dpp v48, v45, v8 row_newbcast:8 row_mask:0xf bank_mask:0xf
  v_and_b32_dpp v49, v45, v9 row_newbcast:8 row_mask:0xf bank_mask:0xf
  v_and_b32_dpp v50, v45, v10 row_newbcast:8 row_mask:0xf bank_mask:0xf
  v_and_b32_dpp v51, v45, v11 row_newbcast:8 row_mask:0xf bank_mask:0xf
  s_nop 1
  v_mfma_f32_16x16x32_bf16 v[56:59], v[104:107], v[48:51], v[56:59]
  s_waitcnt vmcnt(4)
  v_and_b32_dpp v52, v45, v8 row_newbcast:12 row_mask:0xf bank_mask:0xf
  v_and_b32_dpp v53, v45, v9 row_newbcast:12 row_mask:0xf bank_mask:0xf
  v_and_b32_dpp v54, v45, v10 row_newbcast:12 row_mask:0xf bank_mask:0xf
  v_and_b32_dpp v55, v45, v11 row_newbcast:12 row_mask:0xf bank_mask:0xf
  s_nop 1
  v_mfma_f32_16x16x32_bf16 v[56:59], v[108:111], v[52:55], v[56:59]
  s_waitcnt vmcnt(3)
  s_waitcnt lgkmcnt(0)
  v_fma_f32 v43, v39, s24, -v41
  v_exp_f32 v44, v43
  s_nop 0
  v_add_f32 v42, v42, v44
  v_cvt_pk_bf16_f32 v46, v44, v44
  s_nop 0
  v_add_f32_dpp v42, v42, v42 row_ror:4 row_mask:0xf bank_mask:0xf
  s_nop 1
  v_add_f32_dpp v42, v42, v42 row_ror:8 row_mask:0xf bank_mask:0xf
  v_mov_b32 v43, v42
  s_nop 1
  v_permlane16_swap_b32 v43, v42
  v_add_f32 v42, v42, v43
  v_mov_b32 v43, v42
  s_nop 1
  v_permlane32_swap_b32 v43, v42
  v_add_f32 v42, v42, v43
  s_lshl_b32 s26, s3, 3
  v_mov_b32 v6, s26
  v_mov_b32 v4, v41
  v_mov_b32 v5, v42
  s_mov_b64 exec, 1
  ds_write_b64 v6, v[4:5] offset:4096
  s_mov_b64 exec, -1
  v_lshrrev_b32 v5, 4, v1
  v_and_b32 v6, 7, v1
  v_lshl_add_u32 v6, v5, 3, v6
  v_lshlrev_b32 v6, 4, v6
  s_lshl_b32 s26, s3, 9
  v_add_u32 v6, s26, v6
  v_and_b32_dpp v48, v46, v8 row_newbcast:0 row_mask:0xf bank_mask:0xf
  v_and_b32_dpp v49, v46, v9 row_newbcast:0 row_mask:0xf bank_mask:0xf
  v_and_b32_dpp v50, v46, v10 row_newbcast:0 row_mask:0xf bank_mask:0xf
  v_and_b32_dpp v51, v46, v11 row_newbcast:0 row_mask:0xf bank_mask:0xf
  s_nop 1
  v_mfma_f32_16x16x32_bf16 v[56:59], v[112:115], v[48:51], v[56:59]
  s_waitcnt vmcnt(2)
  v_and_b32_dpp v52, v46, v8 row_newbcast:4 row_mask:0xf bank_mask:0xf
  v_and_b32_dpp v53, v46, v9 row_newbcast:4 row_mask:0xf bank_mask:0xf
  v_and_b32_dpp v54, v46, v10 row_newbcast:4 row_mask:0xf bank_mask:0xf
  v_and_b32_dpp v55, v46, v11 row_newbcast:4 row_mask:0xf bank_mask:0xf
  s_nop 1
  v_mfma_f32_16x16x32_bf16 v[56:59], v[116:119], v[52:55], v[56:59]
  s_waitcnt vmcnt(1)
  v_and_b32_dpp v48, v46, v8 row_newbcast:8 row_mask:0xf bank_mask:0xf
  v_and_b32_dpp v49, v46, v9 row_newbcast:8 row_mask:0xf bank_mask:0xf
  v_and_b32_dpp v50, v46, v10 row_newbcast:8 row_mask:0xf bank_mask:0xf
  v_and_b32_dpp v51, v46, v11 row_newbcast:8 row_mask:0xf bank_mask:0xf
  s_nop 1
  v_mfma_f32_16x16x32_bf16 v[56:59], v[120:123], v[48:51], v[56:59]
  s_waitcnt vmcnt(0)
  v_and_b32_dpp v52, v46, v8 row_newbcast:12 row_mask:0xf bank_mask:0xf
  v_and_b32_dpp v53, v46, v9 row_newbcast:12 row_mask:0xf bank_mask:0xf
  v_and_b32_dpp v54, v46, v10 row_newbcast:12 row_mask:0xf bank_mask:0xf
  v_and_b32_dpp v55, v46, v11 row_newbcast:12 row_mask:0xf bank_mask:0xf
  s_nop 1
  v_mfma_f32_16x16x32_bf16 v[56:59], v[124:127], v[52:55], v[56:59]
  s_mov_b32 exec_lo, 0xff00ff
  s_mov_b32 exec_hi, 0xff00ff
  s_nop 5
  ds_write_b128 v6, v[56:59] offset:2048
  s_mov_b64 exec, -1
  s_waitcnt lgkmcnt(0)
  s_barrier
  s_cmp_lg_u32 s3, 3
  s_cbranch_scc1 L_s_noml
  v_mov_b32 v6, 0
  ds_read_b128 v[8:11], v6 offset:4096
  ds_read_b128 v[12:15], v6 offset:4112
  s_waitcnt lgkmcnt(0)
  v_max_f32 v4, v8, v10
  v_max3_f32 v4, v4, v12, v14
  v_sub_f32 v16, v8, v4
  v_exp_f32 v16, v16
  v_sub_f32 v17, v10, v4
  v_exp_f32 v17, v17
  v_sub_f32 v18, v12, v4
  v_exp_f32 v18, v18
  v_sub_f32 v19, v14, v4
  v_exp_f32 v19, v19
  v_mul_f32 v5, v16, v9
  v_fma_f32 v5, v17, v11, v5
  v_fma_f32 v5, v18, v13, v5
  v_fma_f32 v5, v19, v15, v5
  v_mov_b32 v8, v4
  v_mov_b32 v9, s95
  v_mov_b32 v10, v5
  v_mov_b32 v11, s95
  s_lshl_b32 s26, s22, 4
  s_add_u32 s26, s26, 0xa0000
  s_mov_b64 exec, 1
  buffer_store_dwordx4 v[8:11], v6, s[16:19], s26 offen sc1
  s_mov_b64 exec, -1
  s_nop 0
L_s_noml:
  v_lshlrev_b32 v6, 4, v0
  s_mul_i32 s26, s22, 2560
  s_barrier
  s_cmp_eq_u32 s3, 3
  s_cbranch_scc1 L_s_w3
  v_cmp_gt_u32 vcc, 160, v0
  s_nop 0
  s_and_b64 exec, exec, vcc
  ds_read_b128 v[8:11], v6 offset:5120
  ds_read_b128 v[12:15], v6 offset:7680
  ds_read_b128 v[16:19], v6 offset:10240
  ds_read_b128 v[20:23], v6 offset:12800
  s_waitcnt lgkmcnt(0)
  v_add_f32 v8, v8, v12
  v_add_f32 v16, v16, v20
  v_add_f32 v9, v9, v13
  v_add_f32 v17, v17, v21
  v_add_f32 v10, v10, v14
  v_add_f32 v18, v18, v22
  v_add_f32 v11, v11, v15
  v_add_f32 v19, v19, v23
  v_add_f32 v8, v8, v16
  v_add_f32 v9, v9, v17
  v_add_f32 v10, v10, v18
  v_add_f32 v11, v11, v19
  v_and_or_b32 v8, v8, s92, v47
  v_and_or_b32 v9, v9, s92, v47
  v_and_or_b32 v10, v10, s92, v47
  v_and_or_b32 v11, v11, s92, v47
  buffer_store_dwordx4 v[8:11], v6, s[16:19], s26 offen sc1
  s_branch L_s_done
L_s_w3:
  s_cmp_lg_u32 s2, 0
  s_cbranch_scc1 L_s_done
  v_lshlrev_b32 v6, 4, v1
  s_mov_b32 s26, 0xa0000
  s_mov_b32 s28, 65536
L_s_epoll:
  buffer_load_dwordx4 v[8:11], v6, s[16:19], s26 offen offset:0 sc1
  buffer_load_dwordx4 v[12:15], v6, s[16:19], s26 offen offset:1024 sc1
  buffer_load_dwordx4 v[16:19], v6, s[16:19], s26 offen offset:2048 sc1
  buffer_load_dwordx4 v[20:23], v6, s[16:19], s26 offen offset:3072 sc1
  s_waitcnt vmcnt(0)
  v_xor_b32 v9, s95, v9
  v_xor_b32 v11, s95, v11
  v_xor_b32 v13, s95, v13
  v_xor_b32 v15, s95, v15
  v_xor_b32 v17, s95, v17
  v_xor_b32 v19, s95, v19
  v_xor_b32 v21, s95, v21
  v_xor_b32 v23, s95, v23
  v_or3_b32 v4, v9, v11, v13
  v_or3_b32 v4, v4, v15, v17
  v_or3_b32 v4, v4, v19, v21
  v_or_b32 v4, v4, v23
  v_cmp_ne_u32 vcc, 0, v4
  s_nop 1
  s_cbranch_vccz L_s_eset
  s_sleep 4
  s_sub_u32 s28, s28, 1
  s_cmp_lg_u32 s28, 0
  s_cbranch_scc1 L_s_epoll
L_s_eset:
  v_mov_b32 v4, s95
  s_mov_b32 s26, 0xb0000
  s_mov_b64 exec, 1
  buffer_store_dword v4, off, s[16:19], s26 sc1
  s_mov_b64 exec, -1
L_s_done:
  s_endpgm
.section .rodata,"a"
.p2align 6
.amdhsa_kernel gated_mix__mha_block_cached__swiglu_ffn__decode_kernel
  .amdhsa_next_free_vgpr 256
  .amdhsa_next_free_sgpr 100
  .amdhsa_accum_offset 256
  .amdhsa_group_segment_fixed_size 0
  .amdhsa_kernarg_size 104
  .amdhsa_user_sgpr_count 2
  .amdhsa_user_sgpr_kernarg_segment_ptr 1
  .amdhsa_system_sgpr_workgroup_id_x 1
.end_amdhsa_kernel
```
